```python
import torch

def _softmax(x, axis=-1):
    return torch.softmax(x, dim=axis)
def _gelu(x):
    return torch.nn.functional.gelu(x, approximate="tanh")
def _silu(x):
    return torch.nn.functional.silu(x)
def _sigmoid(x):
    return torch.sigmoid(x)
def _layernorm(x, axis=-1, eps=1e-5):
    m = x.mean(dim=axis, keepdim=True)
    v = x.var(dim=axis, keepdim=True, unbiased=False)
    return (x - m) / torch.sqrt(v + eps)
def _scatter_add(tgt, idx, src, axis=0):
    return tgt.clone().index_add_(axis, idx, src)
def _segment_sum(src, seg, n):
    out = torch.zeros((n,) + src.shape[1:], dtype=src.dtype)
    return out.index_add_(0, seg, src)
def _pad(x, pw):
    flat = tuple(v for pair in reversed(pw) for v in pair)
    return torch.nn.functional.pad(x, flat)

kernel_name = 'sequential_preLN__grouped_kv_mqa__geglu_ffn__prompt'

def setup_inputs():

    _w = (lambda a: (lambda t: t.to(torch.bfloat16) if t.is_floating_point() else t)(torch.as_tensor(a)))
    def _A_setup():
        B, S, D, H = 1, 2048, 1024, 32
        Dh = D // H
        return {
            "x": _w((lambda *s: torch.randn(*s, dtype=torch.bfloat16) * 0.05)(B, S, D)),
            "wq": _w((lambda *s: torch.randn(*s, dtype=torch.bfloat16) * 0.05)(D, H * Dh)),
            "wk": _w((lambda *s: torch.randn(*s, dtype=torch.bfloat16) * 0.05)(D, Dh)),
            "wv": _w((lambda *s: torch.randn(*s, dtype=torch.bfloat16) * 0.05)(D, Dh)),
            "wo": _w((lambda *s: torch.randn(*s, dtype=torch.bfloat16) * 0.05)(H * Dh, D)),
        }
    _A_in = _A_setup()

    def _B_setup():
        B, S, D, F = 1, 2048, 1024, 3584
        return {
            "x": _w((lambda *s: torch.randn(*s, dtype=torch.bfloat16) * 0.05)(B, S, D)),
            "w_gate": _w((lambda *s: torch.randn(*s, dtype=torch.bfloat16) * 0.05)(D, F)),
            "w_up": _w((lambda *s: torch.randn(*s, dtype=torch.bfloat16) * 0.05)(D, F)),
            "w_down": _w((lambda *s: torch.randn(*s, dtype=torch.bfloat16) * 0.05)(F, D)),
        }
    _B_in = _B_setup()

    return {
        "A_x": _A_in["x"],
        "A_wq": _A_in["wq"],
        "A_wk": _A_in["wk"],
        "A_wv": _A_in["wv"],
        "A_wo": _A_in["wo"],
        "B_x": _B_in["x"],
        "B_w_gate": _B_in["w_gate"],
        "B_w_up": _B_in["w_up"],
        "B_w_down": _B_in["w_down"],
    }

def reference(A_x, A_wq, A_wk, A_wv, A_wo, B_x, B_w_gate, B_w_up, B_w_down):
    def _A_ref(x, wq, wk, wv, wo):
        B, S, D = x.shape
        H = 32
        Dh = D // H
        q = (lambda x, *d: x.permute(*d))((x @ wq).reshape(B, S, H, Dh), 0, 2, 1, 3)
        k = x @ wk
        v = x @ wv
        scores = torch.einsum("bhqd,bkd->bhqk", q, k) * (Dh ** -0.5)
        p = _softmax(scores, axis=-1)
        o = torch.einsum("bhqk,bkd->bhqd", p, v)
        return (lambda x, *d: x.permute(*d))(o, 0, 2, 1, 3).reshape(B, S, H * Dh) @ wo

    def _B_ref(x, w_gate, w_up, w_down):
        return (_gelu(x @ w_gate) * (x @ w_up)) @ w_down

    x = A_x
    h = x + _A_ref(_layernorm(x, axis=-1), A_wq, A_wk, A_wv, A_wo)
    h2 = h + _B_ref(_layernorm(h, axis=-1), B_w_gate, B_w_up, B_w_down)
    return h2
```

```asm
; @launch kernel=k0_ln_kv_kernel grid=(256,1,1) block=(256,1,1) lds=104960
; @launch kernel=k1_q_attn_kernel grid=(256,1,1) block=(512,1,1) lds=163840
; @launch kernel=k2_wo_kernel grid=(256,1,1) block=(512,1,1) lds=81920
; @launch kernel=k3_gateup_kernel grid=(256,1,1) block=(256,1,1) lds=158720
; @launch kernel=k4_down_kernel grid=(256,1,1) block=(512,1,1) lds=98304
.amdgcn_target "amdgcn-amd-amdhsa--gfx950"
.text
.globl k0_ln_kv_kernel
.p2align 8
.type k0_ln_kv_kernel,@function
k0_ln_kv_kernel:
Lcode_k0_ln_kv_kernel:
    s_cmp_ge_u32 s2, 256
    s_cbranch_scc1 END_k0_ln_kv_kernel_1
    s_load_dwordx2 s[4:5], s[0:1], 0
    s_load_dwordx2 s[8:9], s[0:1], 16
    s_load_dwordx2 s[12:13], s[0:1], 24
    s_load_dwordx2 s[24:25], s[0:1], 8
    s_load_dwordx2 s[28:29], s[0:1], 88
    s_getpc_b64 s[60:61]
PC_k0_ln_kv_kernel_2:
    s_sub_u32 s60, s60, PC_k0_ln_kv_kernel_2-Lcode_k0_ln_kv_kernel
    s_subb_u32 s61, s61, 0
    s_lshr_b32 s62, s2, 3
    s_lshl_b32 s62, s62, 12
    v_and_b32 v124, 0xc0, v0
    v_lshlrev_b32 v124, 4, v124
    v_add_u32 v124, s62, v124
    v_min_u32 v124, Lcode_end-Lcode_k0_ln_kv_kernel-1024, v124
    v_and_b32 v125, 63, v0
    v_lshl_add_u32 v124, v125, 4, v124
    global_load_dwordx4 v[124:127], v124, s[60:61]
    v_lshrrev_b32 v1, 6, v0
    v_and_b32 v2, 63, v0
    s_and_b32 s40, s2, 7
    s_lshr_b32 s41, s2, 3
    s_lshl_b32 s40, s40, 4
    s_lshr_b32 s42, s41, 1
    s_add_u32 s32, s40, s42
    s_and_b32 s43, s41, 1
    v_readfirstlane_b32 s33, v1
    v_lshlrev_b32 v3, 4, v2
    s_lshl_b32 s40, s32, 4
    s_mul_i32 s41, s33, 4
    s_add_u32 s40, s40, s41
    s_lshl_b32 s34, s40, 11
    s_add_u32 s44, s34, 4096
    s_waitcnt lgkmcnt(0)
    s_mov_b32 s6, 4194304
    s_mov_b32 s7, 0x20000
    buffer_load_dwordx4 v[8:11], v3, s[4:7], s34 offen offset:0
    buffer_load_dwordx4 v[12:15], v3, s[4:7], s34 offen offset:1024
    buffer_load_dwordx4 v[16:19], v3, s[4:7], s34 offen offset:2048
    buffer_load_dwordx4 v[20:23], v3, s[4:7], s34 offen offset:3072
    buffer_load_dwordx4 v[24:27], v3, s[4:7], s44 offen offset:0
    buffer_load_dwordx4 v[28:31], v3, s[4:7], s44 offen offset:1024
    buffer_load_dwordx4 v[32:35], v3, s[4:7], s44 offen offset:2048
    buffer_load_dwordx4 v[36:39], v3, s[4:7], s44 offen offset:3072
    v_lshrrev_b32 v4, 2, v2
    v_lshlrev_b32 v4, 6, v4
    v_lshrrev_b32 v5, 5, v2
    v_lshlrev_b32 v5, 1, v5
    v_and_b32 v6, 3, v2
    v_xor_b32 v5, v5, v6
    v_lshl_add_u32 v4, v5, 4, v4
    s_cmp_eq_u32 s43, 1
    s_cselect_b32 s8, s12, s8
    s_cselect_b32 s9, s13, s9
    s_mov_b32 s10, 65536
    s_mov_b32 s11, 0x20000
    s_mov_b32 s26, 2097152
    s_mov_b32 s27, 0x20000
    s_mov_b32 s16, s28
    s_mov_b32 s17, s29
    s_mov_b32 s18, 4194304
    s_mov_b32 s19, 0x20000
    s_add_u32 s20, s28, 4194304
    s_addc_u32 s21, s29, 0
    s_mov_b32 s22, 262144
    s_mov_b32 s23, 0x20000
    s_add_u32 s56, s28, 41943040
    s_addc_u32 s57, s29, 0
    s_mov_b32 s58, 2097152
    s_mov_b32 s59, 0x20000
    s_mul_i32 s35, s33, 16384
    s_add_u32 s36, s35, 0
    s_mov_b32 m0, s36
    s_nop 0
    buffer_load_dwordx4 v4, s[8:11], s36 offen offset:0 lds
    buffer_load_dwordx4 v4, s[8:11], s36 offen offset:1024 lds
    buffer_load_dwordx4 v4, s[8:11], s36 offen offset:2048 lds
    buffer_load_dwordx4 v4, s[8:11], s36 offen offset:3072 lds
    s_add_u32 s36, s35, 4096
    s_mov_b32 m0, s36
    s_nop 0
    buffer_load_dwordx4 v4, s[8:11], s36 offen offset:0 lds
    buffer_load_dwordx4 v4, s[8:11], s36 offen offset:1024 lds
    buffer_load_dwordx4 v4, s[8:11], s36 offen offset:2048 lds
    buffer_load_dwordx4 v4, s[8:11], s36 offen offset:3072 lds
    s_add_u32 s36, s35, 8192
    s_mov_b32 m0, s36
    s_nop 0
    buffer_load_dwordx4 v4, s[8:11], s36 offen offset:0 lds
    buffer_load_dwordx4 v4, s[8:11], s36 offen offset:1024 lds
    buffer_load_dwordx4 v4, s[8:11], s36 offen offset:2048 lds
    buffer_load_dwordx4 v4, s[8:11], s36 offen offset:3072 lds
    s_add_u32 s36, s35, 12288
    s_mov_b32 m0, s36
    s_nop 0
    buffer_load_dwordx4 v4, s[8:11], s36 offen offset:0 lds
    buffer_load_dwordx4 v4, s[8:11], s36 offen offset:1024 lds
    buffer_load_dwordx4 v4, s[8:11], s36 offen offset:2048 lds
    buffer_load_dwordx4 v4, s[8:11], s36 offen offset:3072 lds
    s_mul_i32 s40, s2, 4
    s_add_u32 s40, s40, s33
    s_and_b32 s41, s40, 63
    s_mul_i32 s41, s41, 16
    s_lshr_b32 s42, s40, 6
    s_lshl_b32 s42, s42, 7
    s_mul_i32 s52, s40, 2048
    v_lshrrev_b32 v112, 3, v2
    v_add_u32 v112, s41, v112
    v_lshlrev_b32 v112, 11, v112
    v_add_u32 v112, s42, v112
    v_bfe_u32 v113, v2, 4, 1
    v_lshlrev_b32 v113, 2, v113
    v_and_b32 v114, 7, v2
    v_xor_b32 v113, v113, v114
    v_lshl_add_u32 v112, v113, 4, v112
    s_mov_b32 s53, 16384
    buffer_load_dwordx4 v[116:119], v112, s[24:27], 0 offen
    buffer_load_dwordx4 v[120:123], v112, s[24:27], s53 offen
    s_waitcnt vmcnt(18)
    v_lshlrev_b32 v48, 16, v8
    v_and_b32 v49, 0xffff0000, v8
    v_lshlrev_b32 v50, 16, v9
    v_and_b32 v51, 0xffff0000, v9
    v_lshlrev_b32 v52, 16, v10
    v_and_b32 v53, 0xffff0000, v10
    v_lshlrev_b32 v54, 16, v11
    v_and_b32 v55, 0xffff0000, v11
    v_lshlrev_b32 v56, 16, v12
    v_and_b32 v57, 0xffff0000, v12
    v_lshlrev_b32 v58, 16, v13
    v_and_b32 v59, 0xffff0000, v13
    v_lshlrev_b32 v60, 16, v14
    v_and_b32 v61, 0xffff0000, v14
    v_lshlrev_b32 v62, 16, v15
    v_and_b32 v63, 0xffff0000, v15
    v_lshlrev_b32 v64, 16, v16
    v_and_b32 v65, 0xffff0000, v16
    v_lshlrev_b32 v66, 16, v17
    v_and_b32 v67, 0xffff0000, v17
    v_lshlrev_b32 v68, 16, v18
    v_and_b32 v69, 0xffff0000, v18
    v_lshlrev_b32 v70, 16, v19
    v_and_b32 v71, 0xffff0000, v19
    v_lshlrev_b32 v72, 16, v20
    v_and_b32 v73, 0xffff0000, v20
    v_lshlrev_b32 v74, 16, v21
    v_and_b32 v75, 0xffff0000, v21
    v_lshlrev_b32 v76, 16, v22
    v_and_b32 v77, 0xffff0000, v22
    v_lshlrev_b32 v78, 16, v23
    v_and_b32 v79, 0xffff0000, v23
    v_lshlrev_b32 v80, 16, v24
    v_and_b32 v81, 0xffff0000, v24
    v_lshlrev_b32 v82, 16, v25
    v_and_b32 v83, 0xffff0000, v25
    v_lshlrev_b32 v84, 16, v26
    v_and_b32 v85, 0xffff0000, v26
    v_lshlrev_b32 v86, 16, v27
    v_and_b32 v87, 0xffff0000, v27
    v_lshlrev_b32 v88, 16, v28
    v_and_b32 v89, 0xffff0000, v28
    v_lshlrev_b32 v90, 16, v29
    v_and_b32 v91, 0xffff0000, v29
    v_lshlrev_b32 v92, 16, v30
    v_and_b32 v93, 0xffff0000, v30
    v_lshlrev_b32 v94, 16, v31
    v_and_b32 v95, 0xffff0000, v31
    v_lshlrev_b32 v96, 16, v32
    v_and_b32 v97, 0xffff0000, v32
    v_lshlrev_b32 v98, 16, v33
    v_and_b32 v99, 0xffff0000, v33
    v_lshlrev_b32 v100, 16, v34
    v_and_b32 v101, 0xffff0000, v34
    v_lshlrev_b32 v102, 16, v35
    v_and_b32 v103, 0xffff0000, v35
    v_lshlrev_b32 v104, 16, v36
    v_and_b32 v105, 0xffff0000, v36
    v_lshlrev_b32 v106, 16, v37
    v_and_b32 v107, 0xffff0000, v37
    v_lshlrev_b32 v108, 16, v38
    v_and_b32 v109, 0xffff0000, v38
    v_lshlrev_b32 v110, 16, v39
    v_and_b32 v111, 0xffff0000, v39
    v_pk_add_f32 v[132:133], v[48:49], v[50:51]
    v_pk_add_f32 v[134:135], v[64:65], v[66:67]
    v_pk_add_f32 v[136:137], v[80:81], v[82:83]
    v_pk_add_f32 v[138:139], v[96:97], v[98:99]
    v_pk_add_f32 v[132:133], v[132:133], v[52:53]
    v_pk_add_f32 v[134:135], v[134:135], v[68:69]
    v_pk_add_f32 v[136:137], v[136:137], v[84:85]
    v_pk_add_f32 v[138:139], v[138:139], v[100:101]
    v_pk_add_f32 v[132:133], v[132:133], v[54:55]
    v_pk_add_f32 v[134:135], v[134:135], v[70:71]
    v_pk_add_f32 v[136:137], v[136:137], v[86:87]
    v_pk_add_f32 v[138:139], v[138:139], v[102:103]
    v_pk_add_f32 v[132:133], v[132:133], v[56:57]
    v_pk_add_f32 v[134:135], v[134:135], v[72:73]
    v_pk_add_f32 v[136:137], v[136:137], v[88:89]
    v_pk_add_f32 v[138:139], v[138:139], v[104:105]
    v_pk_add_f32 v[132:133], v[132:133], v[58:59]
    v_pk_add_f32 v[134:135], v[134:135], v[74:75]
    v_pk_add_f32 v[136:137], v[136:137], v[90:91]
    v_pk_add_f32 v[138:139], v[138:139], v[106:107]
    v_pk_add_f32 v[132:133], v[132:133], v[60:61]
    v_pk_add_f32 v[134:135], v[134:135], v[76:77]
    v_pk_add_f32 v[136:137], v[136:137], v[92:93]
    v_pk_add_f32 v[138:139], v[138:139], v[108:109]
    v_pk_add_f32 v[132:133], v[132:133], v[62:63]
    v_pk_add_f32 v[134:135], v[134:135], v[78:79]
    v_pk_add_f32 v[136:137], v[136:137], v[94:95]
    v_pk_add_f32 v[138:139], v[138:139], v[110:111]
    v_add_f32 v40, v132, v133
    v_add_f32 v41, v134, v135
    v_add_f32 v42, v136, v137
    v_add_f32 v43, v138, v139
    v_add_f32_dpp v40, v40, v40 row_shr:1 row_mask:0xf bank_mask:0xf
    v_add_f32_dpp v41, v41, v41 row_shr:1 row_mask:0xf bank_mask:0xf
    v_add_f32_dpp v42, v42, v42 row_shr:1 row_mask:0xf bank_mask:0xf
    v_add_f32_dpp v43, v43, v43 row_shr:1 row_mask:0xf bank_mask:0xf
    v_add_f32_dpp v40, v40, v40 row_shr:2 row_mask:0xf bank_mask:0xf
    v_add_f32_dpp v41, v41, v41 row_shr:2 row_mask:0xf bank_mask:0xf
    v_add_f32_dpp v42, v42, v42 row_shr:2 row_mask:0xf bank_mask:0xf
    v_add_f32_dpp v43, v43, v43 row_shr:2 row_mask:0xf bank_mask:0xf
    v_add_f32_dpp v40, v40, v40 row_shr:4 row_mask:0xf bank_mask:0xf
    v_add_f32_dpp v41, v41, v41 row_shr:4 row_mask:0xf bank_mask:0xf
    v_add_f32_dpp v42, v42, v42 row_shr:4 row_mask:0xf bank_mask:0xf
    v_add_f32_dpp v43, v43, v43 row_shr:4 row_mask:0xf bank_mask:0xf
    v_add_f32_dpp v40, v40, v40 row_shr:8 row_mask:0xf bank_mask:0xf
    v_add_f32_dpp v41, v41, v41 row_shr:8 row_mask:0xf bank_mask:0xf
    v_add_f32_dpp v42, v42, v42 row_shr:8 row_mask:0xf bank_mask:0xf
    v_add_f32_dpp v43, v43, v43 row_shr:8 row_mask:0xf bank_mask:0xf
    v_add_f32_dpp v40, v40, v40 row_bcast:15 row_mask:0xa bank_mask:0xf
    v_add_f32_dpp v41, v41, v41 row_bcast:15 row_mask:0xa bank_mask:0xf
    v_add_f32_dpp v42, v42, v42 row_bcast:15 row_mask:0xa bank_mask:0xf
    v_add_f32_dpp v43, v43, v43 row_bcast:15 row_mask:0xa bank_mask:0xf
    v_add_f32_dpp v40, v40, v40 row_bcast:31 row_mask:0xc bank_mask:0xf
    v_add_f32_dpp v41, v41, v41 row_bcast:31 row_mask:0xc bank_mask:0xf
    v_add_f32_dpp v42, v42, v42 row_bcast:31 row_mask:0xc bank_mask:0xf
    v_add_f32_dpp v43, v43, v43 row_bcast:31 row_mask:0xc bank_mask:0xf
    v_mov_b32 v112, 0x3a800000
    v_mov_b32 v113, 0x3727c5ac
    v_readlane_b32 s48, v40, 63
    v_readlane_b32 s49, v41, 63
    v_readlane_b32 s50, v42, 63
    v_readlane_b32 s51, v43, 63
    s_nop 1
    v_mul_f32 v44, s48, v112
    v_mul_f32 v45, s49, v112
    v_mul_f32 v46, s50, v112
    v_mul_f32 v47, s51, v112
    v_pk_add_f32 v[48:49], v[48:49], v[44:45] op_sel_hi:[1,0] neg_lo:[0,1] neg_hi:[0,1]
    v_pk_add_f32 v[50:51], v[50:51], v[44:45] op_sel_hi:[1,0] neg_lo:[0,1] neg_hi:[0,1]
    v_pk_add_f32 v[52:53], v[52:53], v[44:45] op_sel_hi:[1,0] neg_lo:[0,1] neg_hi:[0,1]
    v_pk_add_f32 v[54:55], v[54:55], v[44:45] op_sel_hi:[1,0] neg_lo:[0,1] neg_hi:[0,1]
    v_pk_add_f32 v[56:57], v[56:57], v[44:45] op_sel_hi:[1,0] neg_lo:[0,1] neg_hi:[0,1]
    v_pk_add_f32 v[58:59], v[58:59], v[44:45] op_sel_hi:[1,0] neg_lo:[0,1] neg_hi:[0,1]
    v_pk_add_f32 v[60:61], v[60:61], v[44:45] op_sel_hi:[1,0] neg_lo:[0,1] neg_hi:[0,1]
    v_pk_add_f32 v[62:63], v[62:63], v[44:45] op_sel_hi:[1,0] neg_lo:[0,1] neg_hi:[0,1]
    v_pk_add_f32 v[64:65], v[64:65], v[44:45] op_sel:[0,1] op_sel_hi:[1,1] neg_lo:[0,1] neg_hi:[0,1]
    v_pk_add_f32 v[66:67], v[66:67], v[44:45] op_sel:[0,1] op_sel_hi:[1,1] neg_lo:[0,1] neg_hi:[0,1]
    v_pk_add_f32 v[68:69], v[68:69], v[44:45] op_sel:[0,1] op_sel_hi:[1,1] neg_lo:[0,1] neg_hi:[0,1]
    v_pk_add_f32 v[70:71], v[70:71], v[44:45] op_sel:[0,1] op_sel_hi:[1,1] neg_lo:[0,1] neg_hi:[0,1]
    v_pk_add_f32 v[72:73], v[72:73], v[44:45] op_sel:[0,1] op_sel_hi:[1,1] neg_lo:[0,1] neg_hi:[0,1]
    v_pk_add_f32 v[74:75], v[74:75], v[44:45] op_sel:[0,1] op_sel_hi:[1,1] neg_lo:[0,1] neg_hi:[0,1]
    v_pk_add_f32 v[76:77], v[76:77], v[44:45] op_sel:[0,1] op_sel_hi:[1,1] neg_lo:[0,1] neg_hi:[0,1]
    v_pk_add_f32 v[78:79], v[78:79], v[44:45] op_sel:[0,1] op_sel_hi:[1,1] neg_lo:[0,1] neg_hi:[0,1]
    v_pk_add_f32 v[80:81], v[80:81], v[46:47] op_sel_hi:[1,0] neg_lo:[0,1] neg_hi:[0,1]
    v_pk_add_f32 v[82:83], v[82:83], v[46:47] op_sel_hi:[1,0] neg_lo:[0,1] neg_hi:[0,1]
    v_pk_add_f32 v[84:85], v[84:85], v[46:47] op_sel_hi:[1,0] neg_lo:[0,1] neg_hi:[0,1]
    v_pk_add_f32 v[86:87], v[86:87], v[46:47] op_sel_hi:[1,0] neg_lo:[0,1] neg_hi:[0,1]
    v_pk_add_f32 v[88:89], v[88:89], v[46:47] op_sel_hi:[1,0] neg_lo:[0,1] neg_hi:[0,1]
    v_pk_add_f32 v[90:91], v[90:91], v[46:47] op_sel_hi:[1,0] neg_lo:[0,1] neg_hi:[0,1]
    v_pk_add_f32 v[92:93], v[92:93], v[46:47] op_sel_hi:[1,0] neg_lo:[0,1] neg_hi:[0,1]
    v_pk_add_f32 v[94:95], v[94:95], v[46:47] op_sel_hi:[1,0] neg_lo:[0,1] neg_hi:[0,1]
    v_pk_add_f32 v[96:97], v[96:97], v[46:47] op_sel:[0,1] op_sel_hi:[1,1] neg_lo:[0,1] neg_hi:[0,1]
    v_pk_add_f32 v[98:99], v[98:99], v[46:47] op_sel:[0,1] op_sel_hi:[1,1] neg_lo:[0,1] neg_hi:[0,1]
    v_pk_add_f32 v[100:101], v[100:101], v[46:47] op_sel:[0,1] op_sel_hi:[1,1] neg_lo:[0,1] neg_hi:[0,1]
    v_pk_add_f32 v[102:103], v[102:103], v[46:47] op_sel:[0,1] op_sel_hi:[1,1] neg_lo:[0,1] neg_hi:[0,1]
    v_pk_add_f32 v[104:105], v[104:105], v[46:47] op_sel:[0,1] op_sel_hi:[1,1] neg_lo:[0,1] neg_hi:[0,1]
    v_pk_add_f32 v[106:107], v[106:107], v[46:47] op_sel:[0,1] op_sel_hi:[1,1] neg_lo:[0,1] neg_hi:[0,1]
    v_pk_add_f32 v[108:109], v[108:109], v[46:47] op_sel:[0,1] op_sel_hi:[1,1] neg_lo:[0,1] neg_hi:[0,1]
    v_pk_add_f32 v[110:111], v[110:111], v[46:47] op_sel:[0,1] op_sel_hi:[1,1] neg_lo:[0,1] neg_hi:[0,1]
    v_pk_mul_f32 v[132:133], v[48:49], v[48:49]
    v_pk_mul_f32 v[134:135], v[64:65], v[64:65]
    v_pk_mul_f32 v[136:137], v[80:81], v[80:81]
    v_pk_mul_f32 v[138:139], v[96:97], v[96:97]
    v_pk_fma_f32 v[132:133], v[50:51], v[50:51], v[132:133]
    v_pk_fma_f32 v[134:135], v[66:67], v[66:67], v[134:135]
    v_pk_fma_f32 v[136:137], v[82:83], v[82:83], v[136:137]
    v_pk_fma_f32 v[138:139], v[98:99], v[98:99], v[138:139]
    v_pk_fma_f32 v[132:133], v[52:53], v[52:53], v[132:133]
    v_pk_fma_f32 v[134:135], v[68:69], v[68:69], v[134:135]
    v_pk_fma_f32 v[136:137], v[84:85], v[84:85], v[136:137]
    v_pk_fma_f32 v[138:139], v[100:101], v[100:101], v[138:139]
    v_pk_fma_f32 v[132:133], v[54:55], v[54:55], v[132:133]
    v_pk_fma_f32 v[134:135], v[70:71], v[70:71], v[134:135]
    v_pk_fma_f32 v[136:137], v[86:87], v[86:87], v[136:137]
    v_pk_fma_f32 v[138:139], v[102:103], v[102:103], v[138:139]
    v_pk_fma_f32 v[132:133], v[56:57], v[56:57], v[132:133]
    v_pk_fma_f32 v[134:135], v[72:73], v[72:73], v[134:135]
    v_pk_fma_f32 v[136:137], v[88:89], v[88:89], v[136:137]
    v_pk_fma_f32 v[138:139], v[104:105], v[104:105], v[138:139]
    v_pk_fma_f32 v[132:133], v[58:59], v[58:59], v[132:133]
    v_pk_fma_f32 v[134:135], v[74:75], v[74:75], v[134:135]
    v_pk_fma_f32 v[136:137], v[90:91], v[90:91], v[136:137]
    v_pk_fma_f32 v[138:139], v[106:107], v[106:107], v[138:139]
    v_pk_fma_f32 v[132:133], v[60:61], v[60:61], v[132:133]
    v_pk_fma_f32 v[134:135], v[76:77], v[76:77], v[134:135]
    v_pk_fma_f32 v[136:137], v[92:93], v[92:93], v[136:137]
    v_pk_fma_f32 v[138:139], v[108:109], v[108:109], v[138:139]
    v_pk_fma_f32 v[132:133], v[62:63], v[62:63], v[132:133]
    v_pk_fma_f32 v[134:135], v[78:79], v[78:79], v[134:135]
    v_pk_fma_f32 v[136:137], v[94:95], v[94:95], v[136:137]
    v_pk_fma_f32 v[138:139], v[110:111], v[110:111], v[138:139]
    v_add_f32 v40, v132, v133
    v_add_f32 v41, v134, v135
    v_add_f32 v42, v136, v137
    v_add_f32 v43, v138, v139
    v_add_f32_dpp v40, v40, v40 row_shr:1 row_mask:0xf bank_mask:0xf
    v_add_f32_dpp v41, v41, v41 row_shr:1 row_mask:0xf bank_mask:0xf
    v_add_f32_dpp v42, v42, v42 row_shr:1 row_mask:0xf bank_mask:0xf
    v_add_f32_dpp v43, v43, v43 row_shr:1 row_mask:0xf bank_mask:0xf
    v_add_f32_dpp v40, v40, v40 row_shr:2 row_mask:0xf bank_mask:0xf
    v_add_f32_dpp v41, v41, v41 row_shr:2 row_mask:0xf bank_mask:0xf
    v_add_f32_dpp v42, v42, v42 row_shr:2 row_mask:0xf bank_mask:0xf
    v_add_f32_dpp v43, v43, v43 row_shr:2 row_mask:0xf bank_mask:0xf
    v_add_f32_dpp v40, v40, v40 row_shr:4 row_mask:0xf bank_mask:0xf
    v_add_f32_dpp v41, v41, v41 row_shr:4 row_mask:0xf bank_mask:0xf
    v_add_f32_dpp v42, v42, v42 row_shr:4 row_mask:0xf bank_mask:0xf
    v_add_f32_dpp v43, v43, v43 row_shr:4 row_mask:0xf bank_mask:0xf
    v_add_f32_dpp v40, v40, v40 row_shr:8 row_mask:0xf bank_mask:0xf
    v_add_f32_dpp v41, v41, v41 row_shr:8 row_mask:0xf bank_mask:0xf
    v_add_f32_dpp v42, v42, v42 row_shr:8 row_mask:0xf bank_mask:0xf
    v_add_f32_dpp v43, v43, v43 row_shr:8 row_mask:0xf bank_mask:0xf
    v_add_f32_dpp v40, v40, v40 row_bcast:15 row_mask:0xa bank_mask:0xf
    v_add_f32_dpp v41, v41, v41 row_bcast:15 row_mask:0xa bank_mask:0xf
    v_add_f32_dpp v42, v42, v42 row_bcast:15 row_mask:0xa bank_mask:0xf
    v_add_f32_dpp v43, v43, v43 row_bcast:15 row_mask:0xa bank_mask:0xf
    v_add_f32_dpp v40, v40, v40 row_bcast:31 row_mask:0xc bank_mask:0xf
    v_add_f32_dpp v41, v41, v41 row_bcast:31 row_mask:0xc bank_mask:0xf
    v_add_f32_dpp v42, v42, v42 row_bcast:31 row_mask:0xc bank_mask:0xf
    v_add_f32_dpp v43, v43, v43 row_bcast:31 row_mask:0xc bank_mask:0xf
    s_nop 0
    v_readlane_b32 s48, v40, 63
    v_readlane_b32 s49, v41, 63
    v_readlane_b32 s50, v42, 63
    v_readlane_b32 s51, v43, 63
    s_nop 1
    v_fma_f32 v44, s48, v112, v113
    v_fma_f32 v45, s49, v112, v113
    v_fma_f32 v46, s50, v112, v113
    v_fma_f32 v47, s51, v112, v113
    v_rsq_f32 v44, v44
    v_rsq_f32 v45, v45
    v_rsq_f32 v46, v46
    v_rsq_f32 v47, v47
    s_nop 0
    v_pk_mul_f32 v[48:49], v[48:49], v[44:45] op_sel_hi:[1,0]
    v_pk_mul_f32 v[50:51], v[50:51], v[44:45] op_sel_hi:[1,0]
    v_pk_mul_f32 v[52:53], v[52:53], v[44:45] op_sel_hi:[1,0]
    v_pk_mul_f32 v[54:55], v[54:55], v[44:45] op_sel_hi:[1,0]
    v_pk_mul_f32 v[56:57], v[56:57], v[44:45] op_sel_hi:[1,0]
    v_pk_mul_f32 v[58:59], v[58:59], v[44:45] op_sel_hi:[1,0]
    v_pk_mul_f32 v[60:61], v[60:61], v[44:45] op_sel_hi:[1,0]
    v_pk_mul_f32 v[62:63], v[62:63], v[44:45] op_sel_hi:[1,0]
    v_pk_mul_f32 v[64:65], v[64:65], v[44:45] op_sel:[0,1] op_sel_hi:[1,1]
    v_pk_mul_f32 v[66:67], v[66:67], v[44:45] op_sel:[0,1] op_sel_hi:[1,1]
    v_pk_mul_f32 v[68:69], v[68:69], v[44:45] op_sel:[0,1] op_sel_hi:[1,1]
    v_pk_mul_f32 v[70:71], v[70:71], v[44:45] op_sel:[0,1] op_sel_hi:[1,1]
    v_pk_mul_f32 v[72:73], v[72:73], v[44:45] op_sel:[0,1] op_sel_hi:[1,1]
    v_pk_mul_f32 v[74:75], v[74:75], v[44:45] op_sel:[0,1] op_sel_hi:[1,1]
    v_pk_mul_f32 v[76:77], v[76:77], v[44:45] op_sel:[0,1] op_sel_hi:[1,1]
    v_pk_mul_f32 v[78:79], v[78:79], v[44:45] op_sel:[0,1] op_sel_hi:[1,1]
    v_pk_mul_f32 v[80:81], v[80:81], v[46:47] op_sel_hi:[1,0]
    v_pk_mul_f32 v[82:83], v[82:83], v[46:47] op_sel_hi:[1,0]
    v_pk_mul_f32 v[84:85], v[84:85], v[46:47] op_sel_hi:[1,0]
    v_pk_mul_f32 v[86:87], v[86:87], v[46:47] op_sel_hi:[1,0]
    v_pk_mul_f32 v[88:89], v[88:89], v[46:47] op_sel_hi:[1,0]
    v_pk_mul_f32 v[90:91], v[90:91], v[46:47] op_sel_hi:[1,0]
    v_pk_mul_f32 v[92:93], v[92:93], v[46:47] op_sel_hi:[1,0]
    v_pk_mul_f32 v[94:95], v[94:95], v[46:47] op_sel_hi:[1,0]
    v_pk_mul_f32 v[96:97], v[96:97], v[46:47] op_sel:[0,1] op_sel_hi:[1,1]
    v_pk_mul_f32 v[98:99], v[98:99], v[46:47] op_sel:[0,1] op_sel_hi:[1,1]
    v_pk_mul_f32 v[100:101], v[100:101], v[46:47] op_sel:[0,1] op_sel_hi:[1,1]
    v_pk_mul_f32 v[102:103], v[102:103], v[46:47] op_sel:[0,1] op_sel_hi:[1,1]
    v_pk_mul_f32 v[104:105], v[104:105], v[46:47] op_sel:[0,1] op_sel_hi:[1,1]
    v_pk_mul_f32 v[106:107], v[106:107], v[46:47] op_sel:[0,1] op_sel_hi:[1,1]
    v_pk_mul_f32 v[108:109], v[108:109], v[46:47] op_sel:[0,1] op_sel_hi:[1,1]
    v_pk_mul_f32 v[110:111], v[110:111], v[46:47] op_sel:[0,1] op_sel_hi:[1,1]
    v_cvt_pk_bf16_f32 v8, v48, v49
    v_cvt_pk_bf16_f32 v9, v50, v51
    v_cvt_pk_bf16_f32 v10, v52, v53
    v_cvt_pk_bf16_f32 v11, v54, v55
    v_cvt_pk_bf16_f32 v12, v56, v57
    v_cvt_pk_bf16_f32 v13, v58, v59
    v_cvt_pk_bf16_f32 v14, v60, v61
    v_cvt_pk_bf16_f32 v15, v62, v63
    v_cvt_pk_bf16_f32 v16, v64, v65
    v_cvt_pk_bf16_f32 v17, v66, v67
    v_cvt_pk_bf16_f32 v18, v68, v69
    v_cvt_pk_bf16_f32 v19, v70, v71
    v_cvt_pk_bf16_f32 v20, v72, v73
    v_cvt_pk_bf16_f32 v21, v74, v75
    v_cvt_pk_bf16_f32 v22, v76, v77
    v_cvt_pk_bf16_f32 v23, v78, v79
    v_cvt_pk_bf16_f32 v24, v80, v81
    v_cvt_pk_bf16_f32 v25, v82, v83
    v_cvt_pk_bf16_f32 v26, v84, v85
    v_cvt_pk_bf16_f32 v27, v86, v87
    v_cvt_pk_bf16_f32 v28, v88, v89
    v_cvt_pk_bf16_f32 v29, v90, v91
    v_cvt_pk_bf16_f32 v30, v92, v93
    v_cvt_pk_bf16_f32 v31, v94, v95
    v_cvt_pk_bf16_f32 v32, v96, v97
    v_cvt_pk_bf16_f32 v33, v98, v99
    v_cvt_pk_bf16_f32 v34, v100, v101
    v_cvt_pk_bf16_f32 v35, v102, v103
    v_cvt_pk_bf16_f32 v36, v104, v105
    v_cvt_pk_bf16_f32 v37, v106, v107
    v_cvt_pk_bf16_f32 v38, v108, v109
    v_cvt_pk_bf16_f32 v39, v110, v111
    s_mul_i32 s40, s33, 8320
    s_add_u32 s40, s40, 65536
    v_add_u32 v5, s40, v3
    ds_write_b128 v5, v[8:11] offset:0
    ds_write_b128 v5, v[12:15] offset:1024
    ds_write_b128 v5, v[16:19] offset:2080
    ds_write_b128 v5, v[20:23] offset:3104
    ds_write_b128 v5, v[24:27] offset:4160
    ds_write_b128 v5, v[28:31] offset:5184
    ds_write_b128 v5, v[32:35] offset:6240
    ds_write_b128 v5, v[36:39] offset:7264
    s_and_b32 s41, s33, 1
    s_lshr_b32 s42, s33, 1
    v_lshrrev_b32 v6, 4, v2
    v_and_b32 v7, 15, v2
    v_lshrrev_b32 v44, 2, v7
    v_and_b32 v45, 3, v2
    v_lshl_add_u32 v44, v6, 3, v44
    v_lshlrev_b32 v44, 6, v44
    v_lshrrev_b32 v46, 1, v45
    s_lshl_b32 s45, s41, 1
    v_add_u32 v46, s45, v46
    v_and_b32 v47, 1, v6
    v_lshlrev_b32 v47, 1, v47
    v_xor_b32 v46, v46, v47
    v_lshl_add_u32 v44, v46, 4, v44
    v_and_b32 v47, 1, v45
    v_lshl_add_u32 v44, v47, 3, v44
    s_mul_i32 s45, s42, 32768
    v_add_u32 v44, s45, v44
    v_mul_u32_u24 v46, 2080, v7
    v_lshl_add_u32 v46, v6, 4, v46
    s_mul_i32 s45, s42, 1024
    s_add_u32 s45, s45, 65536
    v_add_u32 v45, s45, v46
    s_waitcnt vmcnt(0) lgkmcnt(0)
    buffer_store_dwordx4 v[116:119], v3, s[56:59], s52 offen sc1
    buffer_store_dwordx4 v[120:123], v3, s[56:59], s52 offen offset:1024 sc1
    s_barrier
    s_lshl_b32 s45, s43, 4
    s_mul_i32 s46, s33, 4
    s_add_u32 s45, s45, s46
    v_mul_u32_u24 v46, 2080, v7
    v_lshl_add_u32 v46, v6, 4, v46
    s_lshl_b32 s46, s45, 6
    s_add_u32 s46, s46, 65536
    v_add_u32 v46, s46, v46
    ds_read_b128 v[96:99], v46 offset:0
    ds_read_b128 v[100:103], v46 offset:64
    ds_read_b128 v[104:107], v46 offset:128
    ds_read_b128 v[108:111], v46 offset:192
    v_lshrrev_b32 v47, 1, v6
    v_lshlrev_b32 v47, 10, v47
    v_and_b32 v112, 1, v6
    v_lshl_add_u32 v47, v112, 9, v47
    v_lshl_add_u32 v47, v7, 4, v47
    s_lshr_b32 s46, s32, 1
    s_lshl_b32 s46, s46, 16
    s_and_b32 s47, s32, 1
    s_lshl_b32 s47, s47, 8
    s_add_u32 s46, s46, s47
    s_lshl_b32 s47, s45, 11
    s_add_u32 s46, s46, s47
    s_waitcnt lgkmcnt(0)
    s_add_u32 s47, s46, 0
    buffer_store_dwordx4 v[96:99], v47, s[16:19], s47 offen sc1
    s_add_u32 s47, s46, 2048
    buffer_store_dwordx4 v[100:103], v47, s[16:19], s47 offen sc1
    s_add_u32 s47, s46, 4096
    buffer_store_dwordx4 v[104:107], v47, s[16:19], s47 offen sc1
    s_add_u32 s47, s46, 6144
    buffer_store_dwordx4 v[108:111], v47, s[16:19], s47 offen sc1
    s_cmp_eq_u32 s43, 1
    s_cbranch_scc1 V_k0_ln_kv_kernel_3
    ds_read_b64_tr_b16 v[48:49], v44 offset:0
    ds_read_b64_tr_b16 v[50:51], v44 offset:256
    ds_read_b128 v[52:55], v45 offset:0
    ds_read_b64_tr_b16 v[56:57], v44 offset:2048
    ds_read_b64_tr_b16 v[58:59], v44 offset:2304
    ds_read_b128 v[60:63], v45 offset:64
    ds_read_b64_tr_b16 v[64:65], v44 offset:4096
    ds_read_b64_tr_b16 v[66:67], v44 offset:4352
    ds_read_b128 v[68:71], v45 offset:128
    ds_read_b64_tr_b16 v[72:73], v44 offset:6144
    ds_read_b64_tr_b16 v[74:75], v44 offset:6400
    ds_read_b128 v[76:79], v45 offset:192
    s_waitcnt lgkmcnt(9)
    v_mfma_f32_16x16x32_bf16 v[40:43], v[48:51], v[52:55], 0
    ds_read_b64_tr_b16 v[48:49], v44 offset:8192
    ds_read_b64_tr_b16 v[50:51], v44 offset:8448
    ds_read_b128 v[52:55], v45 offset:256
    s_waitcnt lgkmcnt(9)
    v_mfma_f32_16x16x32_bf16 v[40:43], v[56:59], v[60:63], v[40:43]
    ds_read_b64_tr_b16 v[56:57], v44 offset:10240
    ds_read_b64_tr_b16 v[58:59], v44 offset:10496
    ds_read_b128 v[60:63], v45 offset:320
    s_waitcnt lgkmcnt(9)
    v_mfma_f32_16x16x32_bf16 v[40:43], v[64:67], v[68:71], v[40:43]
    ds_read_b64_tr_b16 v[64:65], v44 offset:12288
    ds_read_b64_tr_b16 v[66:67], v44 offset:12544
    ds_read_b128 v[68:71], v45 offset:384
    s_waitcnt lgkmcnt(9)
    v_mfma_f32_16x16x32_bf16 v[40:43], v[72:75], v[76:79], v[40:43]
    ds_read_b64_tr_b16 v[72:73], v44 offset:14336
    ds_read_b64_tr_b16 v[74:75], v44 offset:14592
    ds_read_b128 v[76:79], v45 offset:448
    s_waitcnt lgkmcnt(9)
    v_mfma_f32_16x16x32_bf16 v[40:43], v[48:51], v[52:55], v[40:43]
    ds_read_b64_tr_b16 v[48:49], v44 offset:16384
    ds_read_b64_tr_b16 v[50:51], v44 offset:16640
    ds_read_b128 v[52:55], v45 offset:512
    s_waitcnt lgkmcnt(9)
    v_mfma_f32_16x16x32_bf16 v[40:43], v[56:59], v[60:63], v[40:43]
    ds_read_b64_tr_b16 v[56:57], v44 offset:18432
    ds_read_b64_tr_b16 v[58:59], v44 offset:18688
    ds_read_b128 v[60:63], v45 offset:576
    s_waitcnt lgkmcnt(9)
    v_mfma_f32_16x16x32_bf16 v[40:43], v[64:67], v[68:71], v[40:43]
    ds_read_b64_tr_b16 v[64:65], v44 offset:20480
    ds_read_b64_tr_b16 v[66:67], v44 offset:20736
    ds_read_b128 v[68:71], v45 offset:640
    s_waitcnt lgkmcnt(9)
    v_mfma_f32_16x16x32_bf16 v[40:43], v[72:75], v[76:79], v[40:43]
    ds_read_b64_tr_b16 v[72:73], v44 offset:22528
    ds_read_b64_tr_b16 v[74:75], v44 offset:22784
    ds_read_b128 v[76:79], v45 offset:704
    s_waitcnt lgkmcnt(9)
    v_mfma_f32_16x16x32_bf16 v[40:43], v[48:51], v[52:55], v[40:43]
    ds_read_b64_tr_b16 v[48:49], v44 offset:24576
    ds_read_b64_tr_b16 v[50:51], v44 offset:24832
    ds_read_b128 v[52:55], v45 offset:768
    s_waitcnt lgkmcnt(9)
    v_mfma_f32_16x16x32_bf16 v[40:43], v[56:59], v[60:63], v[40:43]
    ds_read_b64_tr_b16 v[56:57], v44 offset:26624
    ds_read_b64_tr_b16 v[58:59], v44 offset:26880
    ds_read_b128 v[60:63], v45 offset:832
    s_waitcnt lgkmcnt(9)
    v_mfma_f32_16x16x32_bf16 v[40:43], v[64:67], v[68:71], v[40:43]
    ds_read_b64_tr_b16 v[64:65], v44 offset:28672
    ds_read_b64_tr_b16 v[66:67], v44 offset:28928
    ds_read_b128 v[68:71], v45 offset:896
    s_waitcnt lgkmcnt(9)
    v_mfma_f32_16x16x32_bf16 v[40:43], v[72:75], v[76:79], v[40:43]
    ds_read_b64_tr_b16 v[72:73], v44 offset:30720
    ds_read_b64_tr_b16 v[74:75], v44 offset:30976
    ds_read_b128 v[76:79], v45 offset:960
    s_waitcnt lgkmcnt(9)
    v_mfma_f32_16x16x32_bf16 v[40:43], v[48:51], v[52:55], v[40:43]
    s_waitcnt lgkmcnt(6)
    v_mfma_f32_16x16x32_bf16 v[40:43], v[56:59], v[60:63], v[40:43]
    s_waitcnt lgkmcnt(3)
    v_mfma_f32_16x16x32_bf16 v[40:43], v[64:67], v[68:71], v[40:43]
    s_waitcnt lgkmcnt(0)
    v_mfma_f32_16x16x32_bf16 v[40:43], v[72:75], v[76:79], v[40:43]
    s_lshl_b32 s45, s42, 1
    s_add_u32 s45, s45, s41
    s_lshl_b32 s45, s45, 10
    s_add_u32 s45, s45, 96768
    v_add_u32 v46, s45, v3
    s_nop 3
    s_cmp_eq_u32 s42, 0
    s_cbranch_scc1 RED_k0_ln_kv_kernel_5
    ds_write_b128 v46, v[40:43]
    s_waitcnt lgkmcnt(0)
    s_barrier
    s_branch EPI_k0_ln_kv_kernel_4
RED_k0_ln_kv_kernel_5:
    s_barrier
    ds_read_b128 v[48:51], v46 offset:2048
    s_waitcnt lgkmcnt(0)
    v_add_f32 v40, v40, v48
    v_add_f32 v41, v41, v49
    v_add_f32 v42, v42, v50
    v_add_f32 v43, v43, v51
    v_bfe_u32 v64, v7, 2, 1
    v_lshrrev_b32 v65, 3, v7
    v_and_b32 v66, 3, v7
    v_lshl_add_u32 v66, v64, 3, v66
    v_lshl_add_u32 v66, v65, 2, v66
    s_and_b32 s44, s32, 1
    s_lshl_b32 s44, s44, 4
    v_add_u32 v66, s44, v66
    v_lshlrev_b32 v67, 6, v66
    v_lshrrev_b32 v68, 1, v6
    v_lshlrev_b32 v68, 1, v68
    v_add_u32 v68, s41, v68
    v_bfe_u32 v65, v66, 2, 2
    v_xor_b32 v68, v68, v65
    v_lshl_add_u32 v67, v68, 4, v67
    v_and_b32 v68, 1, v6
    v_lshl_add_u32 v67, v68, 3, v67
    s_lshr_b32 s44, s32, 1
    s_lshl_b32 s44, s44, 12
    v_cvt_pk_bf16_f32 v40, v40, v41
    v_cvt_pk_bf16_f32 v41, v42, v43
    buffer_store_dwordx2 v[40:41], v67, s[20:23], s44 offen
    s_branch EPI_k0_ln_kv_kernel_4
V_k0_ln_kv_kernel_3:
    ds_read_b64_tr_b16 v[48:49], v44 offset:0
    ds_read_b64_tr_b16 v[50:51], v44 offset:256
    ds_read_b128 v[52:55], v45 offset:0
    ds_read_b64_tr_b16 v[56:57], v44 offset:2048
    ds_read_b64_tr_b16 v[58:59], v44 offset:2304
    ds_read_b128 v[60:63], v45 offset:64
    ds_read_b64_tr_b16 v[64:65], v44 offset:4096
    ds_read_b64_tr_b16 v[66:67], v44 offset:4352
    ds_read_b128 v[68:71], v45 offset:128
    ds_read_b64_tr_b16 v[72:73], v44 offset:6144
    ds_read_b64_tr_b16 v[74:75], v44 offset:6400
    ds_read_b128 v[76:79], v45 offset:192
    s_waitcnt lgkmcnt(9)
    v_mfma_f32_16x16x32_bf16 v[40:43], v[52:55], v[48:51], 0
    ds_read_b64_tr_b16 v[48:49], v44 offset:8192
    ds_read_b64_tr_b16 v[50:51], v44 offset:8448
    ds_read_b128 v[52:55], v45 offset:256
    s_waitcnt lgkmcnt(9)
    v_mfma_f32_16x16x32_bf16 v[40:43], v[60:63], v[56:59], v[40:43]
    ds_read_b64_tr_b16 v[56:57], v44 offset:10240
    ds_read_b64_tr_b16 v[58:59], v44 offset:10496
    ds_read_b128 v[60:63], v45 offset:320
    s_waitcnt lgkmcnt(9)
    v_mfma_f32_16x16x32_bf16 v[40:43], v[68:71], v[64:67], v[40:43]
    ds_read_b64_tr_b16 v[64:65], v44 offset:12288
    ds_read_b64_tr_b16 v[66:67], v44 offset:12544
    ds_read_b128 v[68:71], v45 offset:384
    s_waitcnt lgkmcnt(9)
    v_mfma_f32_16x16x32_bf16 v[40:43], v[76:79], v[72:75], v[40:43]
    ds_read_b64_tr_b16 v[72:73], v44 offset:14336
    ds_read_b64_tr_b16 v[74:75], v44 offset:14592
    ds_read_b128 v[76:79], v45 offset:448
    s_waitcnt lgkmcnt(9)
    v_mfma_f32_16x16x32_bf16 v[40:43], v[52:55], v[48:51], v[40:43]
    ds_read_b64_tr_b16 v[48:49], v44 offset:16384
    ds_read_b64_tr_b16 v[50:51], v44 offset:16640
    ds_read_b128 v[52:55], v45 offset:512
    s_waitcnt lgkmcnt(9)
    v_mfma_f32_16x16x32_bf16 v[40:43], v[60:63], v[56:59], v[40:43]
    ds_read_b64_tr_b16 v[56:57], v44 offset:18432
    ds_read_b64_tr_b16 v[58:59], v44 offset:18688
    ds_read_b128 v[60:63], v45 offset:576
    s_waitcnt lgkmcnt(9)
    v_mfma_f32_16x16x32_bf16 v[40:43], v[68:71], v[64:67], v[40:43]
    ds_read_b64_tr_b16 v[64:65], v44 offset:20480
    ds_read_b64_tr_b16 v[66:67], v44 offset:20736
    ds_read_b128 v[68:71], v45 offset:640
    s_waitcnt lgkmcnt(9)
    v_mfma_f32_16x16x32_bf16 v[40:43], v[76:79], v[72:75], v[40:43]
    ds_read_b64_tr_b16 v[72:73], v44 offset:22528
    ds_read_b64_tr_b16 v[74:75], v44 offset:22784
    ds_read_b128 v[76:79], v45 offset:704
    s_waitcnt lgkmcnt(9)
    v_mfma_f32_16x16x32_bf16 v[40:43], v[52:55], v[48:51], v[40:43]
    ds_read_b64_tr_b16 v[48:49], v44 offset:24576
    ds_read_b64_tr_b16 v[50:51], v44 offset:24832
    ds_read_b128 v[52:55], v45 offset:768
    s_waitcnt lgkmcnt(9)
    v_mfma_f32_16x16x32_bf16 v[40:43], v[60:63], v[56:59], v[40:43]
    ds_read_b64_tr_b16 v[56:57], v44 offset:26624
    ds_read_b64_tr_b16 v[58:59], v44 offset:26880
    ds_read_b128 v[60:63], v45 offset:832
    s_waitcnt lgkmcnt(9)
    v_mfma_f32_16x16x32_bf16 v[40:43], v[68:71], v[64:67], v[40:43]
    ds_read_b64_tr_b16 v[64:65], v44 offset:28672
    ds_read_b64_tr_b16 v[66:67], v44 offset:28928
    ds_read_b128 v[68:71], v45 offset:896
    s_waitcnt lgkmcnt(9)
    v_mfma_f32_16x16x32_bf16 v[40:43], v[76:79], v[72:75], v[40:43]
    ds_read_b64_tr_b16 v[72:73], v44 offset:30720
    ds_read_b64_tr_b16 v[74:75], v44 offset:30976
    ds_read_b128 v[76:79], v45 offset:960
    s_waitcnt lgkmcnt(9)
    v_mfma_f32_16x16x32_bf16 v[40:43], v[52:55], v[48:51], v[40:43]
    s_waitcnt lgkmcnt(6)
    v_mfma_f32_16x16x32_bf16 v[40:43], v[60:63], v[56:59], v[40:43]
    s_waitcnt lgkmcnt(3)
    v_mfma_f32_16x16x32_bf16 v[40:43], v[68:71], v[64:67], v[40:43]
    s_waitcnt lgkmcnt(0)
    v_mfma_f32_16x16x32_bf16 v[40:43], v[76:79], v[72:75], v[40:43]
    s_lshl_b32 s45, s42, 1
    s_add_u32 s45, s45, s41
    s_lshl_b32 s45, s45, 10
    s_add_u32 s45, s45, 96768
    v_add_u32 v46, s45, v3
    s_nop 3
    s_cmp_eq_u32 s42, 0
    s_cbranch_scc1 RED_k0_ln_kv_kernel_6
    ds_write_b128 v46, v[40:43]
    s_waitcnt lgkmcnt(0)
    s_barrier
    s_branch EPI_k0_ln_kv_kernel_4
RED_k0_ln_kv_kernel_6:
    s_barrier
    ds_read_b128 v[48:51], v46 offset:2048
    s_waitcnt lgkmcnt(0)
    v_add_f32 v40, v40, v48
    v_add_f32 v41, v41, v49
    v_add_f32 v42, v42, v50
    v_add_f32 v43, v43, v51
    v_lshrrev_b32 v65, 2, v7
    v_and_b32 v66, 3, v7
    v_lshl_add_u32 v66, v65, 3, v66
    s_lshl_b32 s44, s41, 2
    v_add_u32 v66, s44, v66
    v_lshlrev_b32 v67, 6, v66
    v_lshlrev_b32 v65, 1, v65
    v_add_u32 v65, s41, v65
    v_and_b32 v65, 3, v65
    v_lshrrev_b32 v68, 1, v6
    s_and_b32 s44, s32, 1
    s_lshl_b32 s44, s44, 1
    v_add_u32 v68, s44, v68
    v_xor_b32 v65, v68, v65
    v_lshl_add_u32 v67, v65, 4, v67
    v_and_b32 v68, 1, v6
    v_lshl_add_u32 v67, v68, 3, v67
    s_lshr_b32 s44, s32, 1
    s_lshl_b32 s44, s44, 12
    s_add_u32 s44, s44, 2048
    v_cvt_pk_bf16_f32 v40, v40, v41
    v_cvt_pk_bf16_f32 v41, v42, v43
    buffer_store_dwordx2 v[40:41], v67, s[20:23], s44 offen
EPI_k0_ln_kv_kernel_4:
    s_waitcnt vmcnt(0)
END_k0_ln_kv_kernel_1:
    s_endpgm

.globl k1_q_attn_kernel
.p2align 8
.type k1_q_attn_kernel,@function
k1_q_attn_kernel:
Lcode_k1_q_attn_kernel:
    s_cmp_ge_u32 s2, 256
    s_cbranch_scc1 END_k1_q_attn_kernel_1
    s_load_dwordx2 s[28:29], s[0:1], 88
    s_load_dwordx2 s[20:21], s[0:1], 48
    s_load_dwordx2 s[22:23], s[0:1], 56
    s_load_dwordx2 s[48:49], s[0:1], 32
    s_load_dwordx2 s[52:53], s[0:1], 64
    v_lshrrev_b32 v1, 6, v0
    v_and_b32 v2, 63, v0
    s_and_b32 s30, s2, 7
    s_lshr_b32 s31, s2, 3
    s_lshr_b32 s32, s30, 1
    s_lshl_b32 s32, s32, 2
    s_and_b32 s34, s31, 3
    s_add_u32 s34, s34, s32
    s_and_b32 s32, s30, 1
    s_lshl_b32 s32, s32, 3
    s_lshr_b32 s35, s31, 2
    s_add_u32 s35, s35, s32
    v_readfirstlane_b32 s58, v1
    v_lshlrev_b32 v3, 4, v2
    s_and_b32 s33, s58, 3
    s_lshl_b32 s37, s35, 7
    s_lshl_b32 s38, s33, 13
    s_cmp_lt_u32 s58, 4
    s_cbranch_scc1 CONS_k1_q_attn_kernel_23
    s_lshl_b32 s36, s35, 17
    s_lshl_b32 s47, s33, 11
    s_add_u32 s47, s47, s36
    v_lshlrev_b32 v60, 4, v2
    v_add_u32 v8, s47, v60
    s_lshl_b32 s46, s33, 11
    s_mov_b32 s42, 98304
    s_mov_b32 s41, 0
    s_waitcnt lgkmcnt(0)
    s_add_u32 s8, s28, 41943040
    s_addc_u32 s9, s29, 0
    s_mov_b32 s10, 2097152
    s_mov_b32 s11, 0x20000
    s_add_u32 s12, s28, 4194304
    s_addc_u32 s13, s29, 0
    s_mov_b32 s14, 262144
    s_mov_b32 s15, 0x20000
    s_add_u32 s16, s28, 5242880
    s_addc_u32 s17, s29, 0
    s_mov_b32 s18, 4194304
    s_mov_b32 s19, 0x20000
    s_add_u32 m0, s42, s46
    s_nop 0
    buffer_load_dwordx4 v8, s[8:11], s41 offen offset:0 lds
    buffer_load_dwordx4 v8, s[8:11], s41 offen offset:1024 lds
    s_add_u32 s41, s41, 8192
    s_add_u32 s42, s42, 8192
    s_cmp_eq_u32 s42, 163840
    s_cselect_b32 s42, 98304, s42
    s_add_u32 m0, s42, s46
    s_nop 0
    buffer_load_dwordx4 v8, s[8:11], s41 offen offset:0 lds
    buffer_load_dwordx4 v8, s[8:11], s41 offen offset:1024 lds
    s_add_u32 s41, s41, 8192
    s_add_u32 s42, s42, 8192
    s_cmp_eq_u32 s42, 163840
    s_cselect_b32 s42, 98304, s42
    s_add_u32 m0, s42, s46
    s_nop 0
    buffer_load_dwordx4 v8, s[8:11], s41 offen offset:0 lds
    buffer_load_dwordx4 v8, s[8:11], s41 offen offset:1024 lds
    s_add_u32 s41, s41, 8192
    s_add_u32 s42, s42, 8192
    s_cmp_eq_u32 s42, 163840
    s_cselect_b32 s42, 98304, s42
    s_add_u32 m0, s42, s46
    s_nop 0
    buffer_load_dwordx4 v8, s[8:11], s41 offen offset:0 lds
    buffer_load_dwordx4 v8, s[8:11], s41 offen offset:1024 lds
    s_add_u32 s41, s41, 8192
    s_add_u32 s42, s42, 8192
    s_cmp_eq_u32 s42, 163840
    s_cselect_b32 s42, 98304, s42
    s_add_u32 m0, s42, s46
    s_nop 0
    buffer_load_dwordx4 v8, s[8:11], s41 offen offset:0 lds
    buffer_load_dwordx4 v8, s[8:11], s41 offen offset:1024 lds
    s_add_u32 s41, s41, 8192
    s_add_u32 s42, s42, 8192
    s_cmp_eq_u32 s42, 163840
    s_cselect_b32 s42, 98304, s42
    s_add_u32 m0, s42, s46
    s_nop 0
    buffer_load_dwordx4 v8, s[8:11], s41 offen offset:0 lds
    buffer_load_dwordx4 v8, s[8:11], s41 offen offset:1024 lds
    s_add_u32 s41, s41, 8192
    s_add_u32 s42, s42, 8192
    s_cmp_eq_u32 s42, 163840
    s_cselect_b32 s42, 98304, s42
    s_add_u32 m0, s42, s46
    s_nop 0
    buffer_load_dwordx4 v8, s[8:11], s41 offen offset:0 lds
    buffer_load_dwordx4 v8, s[8:11], s41 offen offset:1024 lds
    s_add_u32 s41, s41, 8192
    s_add_u32 s42, s42, 8192
    s_cmp_eq_u32 s42, 163840
    s_cselect_b32 s42, 98304, s42
    v_and_b32 v4, 31, v2
    v_bfe_u32 v5, v2, 2, 2
    v_lshrrev_b32 v6, 5, v2
    v_xor_b32 v5, v5, v6
    v_lshlrev_b32 v4, 6, v4
    v_lshl_add_u32 v176, v5, 4, v4
    v_xor_b32 v5, 2, v5
    v_lshl_add_u32 v177, v5, 4, v4
    v_mov_b32 v178, v176
    v_mov_b32 v179, v177
    v_bfe_u32 v4, v2, 2, 1
    v_bfe_u32 v5, v2, 4, 1
    v_xor_b32 v4, v4, v5
    v_and_b32 v5, 3, v2
    v_or_b32 v4, v4, v5
    v_mov_b32 v5, 0x3f803f80
    v_cmp_eq_u32 vcc, 0, v4
    s_nop 1
    v_cndmask_b32 v172, 0, v5, vcc
    v_mov_b32 v173, v172
    v_mov_b32 v174, v172
    v_mov_b32 v175, v172
    s_lshl_b32 s47, s34, 2
    s_add_u32 s47, s47, s33
    s_lshl_b32 s47, s47, 6
    s_lshr_b32 s30, s58, 2
    s_lshl_b32 s31, s35, 1
    s_add_u32 s30, s30, s31
    s_lshl_b32 s30, s30, 1
    s_add_u32 s47, s47, s30
    s_lshl_b32 s47, s47, 10
    v_add_u32 v180, s47, v3
    v_mov_b32 v152, 0
    v_mov_b32 v153, 0
    v_mov_b32 v154, 0
    v_mov_b32 v155, 0
    v_mov_b32 v156, 0
    v_mov_b32 v157, 0
    v_mov_b32 v158, 0
    v_mov_b32 v159, 0
    v_mov_b32 v160, 0
    v_mov_b32 v161, 0
    v_mov_b32 v162, 0
    v_mov_b32 v163, 0
    v_mov_b32 v164, 0
    v_mov_b32 v165, 0
    v_mov_b32 v166, 0
    v_mov_b32 v167, 0
    v_mov_b32 v168, 0
    v_mov_b32 v169, 0
    v_mov_b32 v170, 0
    v_mov_b32 v171, 0
    s_and_b32 s30, s2, 3
    s_lshl_b32 s30, s30, 8
    s_lshl_b32 s31, s33, 6
    s_add_u32 s30, s30, s31
    s_mul_i32 s30, s30, 7168
    s_bfe_u32 s31, s2, 0x50002
    s_mul_i32 s31, s31, 224
    s_add_u32 s30, s30, s31
    v_add_u32 v5, 0, v2
    v_mul_u32_u24 v6, 4682, v5
    v_lshrrev_b32 v6, 16, v6
    v_mul_u32_u24 v7, 14, v6
    v_sub_u32 v7, v5, v7
    v_mul_u32_u24 v6, 7168, v6
    v_lshl_add_u32 v6, v7, 4, v6
    v_add_u32 v188, s30, v6
    v_add_u32 v5, 64, v2
    v_mul_u32_u24 v6, 4682, v5
    v_lshrrev_b32 v6, 16, v6
    v_mul_u32_u24 v7, 14, v6
    v_sub_u32 v7, v5, v7
    v_mul_u32_u24 v6, 7168, v6
    v_lshl_add_u32 v6, v7, 4, v6
    v_add_u32 v189, s30, v6
    v_add_u32 v5, 128, v2
    v_mul_u32_u24 v6, 4682, v5
    v_lshrrev_b32 v6, 16, v6
    v_mul_u32_u24 v7, 14, v6
    v_sub_u32 v7, v5, v7
    v_mul_u32_u24 v6, 7168, v6
    v_lshl_add_u32 v6, v7, 4, v6
    v_add_u32 v190, s30, v6
    v_add_u32 v5, 192, v2
    v_mul_u32_u24 v6, 4682, v5
    v_lshrrev_b32 v6, 16, v6
    v_mul_u32_u24 v7, 14, v6
    v_sub_u32 v7, v5, v7
    v_mul_u32_u24 v6, 7168, v6
    v_lshl_add_u32 v6, v7, 4, v6
    v_add_u32 v191, s30, v6
    v_add_u32 v5, 256, v2
    v_mul_u32_u24 v6, 4682, v5
    v_lshrrev_b32 v6, 16, v6
    v_mul_u32_u24 v7, 14, v6
    v_sub_u32 v7, v5, v7
    v_mul_u32_u24 v6, 7168, v6
    v_lshl_add_u32 v6, v7, 4, v6
    v_add_u32 v192, s30, v6
    v_add_u32 v5, 320, v2
    v_mul_u32_u24 v6, 4682, v5
    v_lshrrev_b32 v6, 16, v6
    v_mul_u32_u24 v7, 14, v6
    v_sub_u32 v7, v5, v7
    v_mul_u32_u24 v6, 7168, v6
    v_lshl_add_u32 v6, v7, 4, v6
    v_add_u32 v193, s30, v6
    v_add_u32 v5, 384, v2
    v_mul_u32_u24 v6, 4682, v5
    v_lshrrev_b32 v6, 16, v6
    v_mul_u32_u24 v7, 14, v6
    v_sub_u32 v7, v5, v7
    v_mul_u32_u24 v6, 7168, v6
    v_lshl_add_u32 v6, v7, 4, v6
    v_add_u32 v194, s30, v6
    s_mul_i32 s56, s33, 7168
    s_add_u32 s56, s56, 98304
    v_lshrrev_b32 v5, 2, v2
    v_mul_u32_u24 v5, 224, v5
    v_and_b32 v6, 3, v2
    v_lshl_add_u32 v5, v6, 3, v5
    v_add_u32 v181, s56, v5
    v_mov_b32 v184, 0x3f803f80
    v_mov_b32 v185, 0x3f803f80
    v_mov_b32 v186, 0x3f803f80
    v_mov_b32 v187, 0x3f803f80
    s_lshr_b32 s62, s2, 3
    s_lshl_b32 s62, s62, 16
    s_lshl_b32 s63, s33, 14
    s_add_u32 s62, s62, s63
    s_lshl_b32 s63, s2, 2
    s_add_u32 s63, s63, s33
    s_and_b32 s30, s63, 63
    s_mul_i32 s30, s30, 56
    s_lshr_b32 s31, s63, 6
    s_lshl_b32 s31, s31, 7
    s_mul_i32 s63, s63, 7168
    v_lshrrev_b32 v5, 3, v2
    v_add_u32 v5, s30, v5
    v_lshlrev_b32 v5, 11, v5
    v_add_u32 v5, s31, v5
    v_bfe_u32 v6, v2, 4, 1
    v_lshlrev_b32 v6, 2, v6
    v_and_b32 v7, 7, v2
    v_xor_b32 v6, v6, v7
    v_lshl_add_u32 v182, v6, 4, v5
    s_waitcnt vmcnt(12)
    s_barrier
    s_mov_b32 s39, 9
LD_k1_q_attn_kernel_25:
    s_waitcnt vmcnt(10)
    s_barrier
    s_add_u32 m0, s42, s46
    s_nop 0
    buffer_load_dwordx4 v8, s[8:11], s41 offen offset:0 lds
    buffer_load_dwordx4 v8, s[8:11], s41 offen offset:1024 lds
    s_add_u32 s41, s41, 8192
    s_add_u32 s42, s42, 8192
    s_cmp_eq_u32 s42, 163840
    s_cselect_b32 s42, 98304, s42
    s_sub_u32 s39, s39, 1
    s_cmp_lg_u32 s39, 0
    s_cbranch_scc1 LD_k1_q_attn_kernel_25
    s_waitcnt vmcnt(10)
    s_barrier
    s_waitcnt vmcnt(8)
    s_barrier
    s_waitcnt vmcnt(6)
    s_barrier
    s_waitcnt vmcnt(4)
    s_barrier
    s_add_u32 s47, s38, 0
    s_add_u32 m0, s38, 0
    s_nop 0
    buffer_load_dwordx4 v3, s[12:15], s47 offen offset:0 lds
    buffer_load_dwordx4 v3, s[12:15], s47 offen offset:1024 lds
    buffer_load_dwordx4 v3, s[12:15], s47 offen offset:2048 lds
    buffer_load_dwordx4 v3, s[12:15], s47 offen offset:3072 lds
    s_add_u32 s47, s38, 4096
    s_add_u32 m0, s38, 4096
    s_nop 0
    buffer_load_dwordx4 v3, s[12:15], s47 offen offset:0 lds
    buffer_load_dwordx4 v3, s[12:15], s47 offen offset:1024 lds
    buffer_load_dwordx4 v3, s[12:15], s47 offen offset:2048 lds
    buffer_load_dwordx4 v3, s[12:15], s47 offen offset:3072 lds
    s_waitcnt vmcnt(10)
    s_barrier
    s_waitcnt vmcnt(8)
    s_barrier
    s_waitcnt vmcnt(0)
    s_barrier
    s_lshl_b32 s47, s33, 11
    s_add_u32 s47, s47, 65536
    v_add_u32 v4, s47, v3
    ds_read_b128 v[144:147], v4
    ds_read_b128 v[148:151], v4 offset:1024
    s_add_u32 s47, s38, 32768
    s_add_u32 m0, s38, 32768
    s_nop 0
    buffer_load_dwordx4 v3, s[12:15], s47 offen offset:0 lds
    buffer_load_dwordx4 v3, s[12:15], s47 offen offset:1024 lds
    buffer_load_dwordx4 v3, s[12:15], s47 offen offset:2048 lds
    buffer_load_dwordx4 v3, s[12:15], s47 offen offset:3072 lds
    s_add_u32 s47, s38, 36864
    s_add_u32 m0, s38, 36864
    s_nop 0
    buffer_load_dwordx4 v3, s[12:15], s47 offen offset:0 lds
    buffer_load_dwordx4 v3, s[12:15], s47 offen offset:1024 lds
    buffer_load_dwordx4 v3, s[12:15], s47 offen offset:2048 lds
    buffer_load_dwordx4 v3, s[12:15], s47 offen offset:3072 lds
    s_branch JOIN_k1_q_attn_kernel_24
CONS_k1_q_attn_kernel_23:
    s_lshl_b32 s36, s34, 2
    s_add_u32 s36, s36, s33
    s_lshl_b32 s36, s36, 16
    v_lshlrev_b32 v10, 4, v2
    v_add_u32 v10, s36, v10
    v_lshrrev_b32 v60, 5, v2
    v_lshlrev_b32 v60, 3, v60
    v_bfe_u32 v61, v2, 2, 2
    v_add_u32 v60, v60, v61
    v_lshlrev_b32 v60, 7, v60
    v_and_b32 v61, 1, v2
    v_lshlrev_b32 v61, 1, v61
    v_bfe_u32 v62, v2, 4, 1
    v_add_u32 v61, v61, v62
    v_bfe_u32 v62, v2, 3, 1
    v_lshlrev_b32 v62, 2, v62
    v_xor_b32 v61, v61, v62
    v_bfe_u32 v62, v2, 1, 1
    v_lshlrev_b32 v62, 3, v62
    v_add_u32 v60, v60, v62
    v_add_u32 v60, 98304, v60
    v_lshl_add_u32 v14, v61, 4, v60
    v_xor_b32 v61, 4, v61
    v_lshl_add_u32 v15, v61, 4, v60
    s_mov_b32 s43, 98304
    s_mov_b32 s40, 0
    v_mov_b32 v16, 0
    v_mov_b32 v17, 0
    v_mov_b32 v18, 0
    v_mov_b32 v19, 0
    v_mov_b32 v20, 0
    v_mov_b32 v21, 0
    v_mov_b32 v22, 0
    v_mov_b32 v23, 0
    v_mov_b32 v24, 0
    v_mov_b32 v25, 0
    v_mov_b32 v26, 0
    v_mov_b32 v27, 0
    v_mov_b32 v28, 0
    v_mov_b32 v29, 0
    v_mov_b32 v30, 0
    v_mov_b32 v31, 0
    v_mov_b32 v32, 0
    v_mov_b32 v33, 0
    v_mov_b32 v34, 0
    v_mov_b32 v35, 0
    v_mov_b32 v36, 0
    v_mov_b32 v37, 0
    v_mov_b32 v38, 0
    v_mov_b32 v39, 0
    v_mov_b32 v40, 0
    v_mov_b32 v41, 0
    v_mov_b32 v42, 0
    v_mov_b32 v43, 0
    v_mov_b32 v44, 0
    v_mov_b32 v45, 0
    v_mov_b32 v46, 0
    v_mov_b32 v47, 0
    s_waitcnt lgkmcnt(0)
    s_mov_b32 s4, s28
    s_mov_b32 s5, s29
    s_mov_b32 s6, 4194304
    s_mov_b32 s7, 0x20000
    buffer_load_dwordx4 v[48:51], v10, s[4:7], s40 offen offset:0
    buffer_load_dwordx4 v[52:55], v10, s[4:7], s40 offen offset:1024
    buffer_load_dwordx4 v[56:59], v10, s[4:7], s40 offen offset:2048
    buffer_load_dwordx4 v[60:63], v10, s[4:7], s40 offen offset:3072
    s_add_u32 s40, s40, 4096
    buffer_load_dwordx4 v[64:67], v10, s[4:7], s40 offen offset:0
    buffer_load_dwordx4 v[68:71], v10, s[4:7], s40 offen offset:1024
    buffer_load_dwordx4 v[72:75], v10, s[4:7], s40 offen offset:2048
    buffer_load_dwordx4 v[76:79], v10, s[4:7], s40 offen offset:3072
    s_add_u32 s40, s40, 4096
    buffer_load_dwordx4 v[80:83], v10, s[4:7], s40 offen offset:0
    buffer_load_dwordx4 v[84:87], v10, s[4:7], s40 offen offset:1024
    buffer_load_dwordx4 v[88:91], v10, s[4:7], s40 offen offset:2048
    buffer_load_dwordx4 v[92:95], v10, s[4:7], s40 offen offset:3072
    s_add_u32 s40, s40, 4096
    buffer_load_dwordx4 v[96:99], v10, s[4:7], s40 offen offset:0
    buffer_load_dwordx4 v[100:103], v10, s[4:7], s40 offen offset:1024
    buffer_load_dwordx4 v[104:107], v10, s[4:7], s40 offen offset:2048
    buffer_load_dwordx4 v[108:111], v10, s[4:7], s40 offen offset:3072
    s_add_u32 s40, s40, 4096
    v_and_b32 v4, 31, v2
    v_bfe_u32 v5, v2, 2, 2
    v_lshrrev_b32 v6, 5, v2
    v_xor_b32 v5, v5, v6
    v_lshlrev_b32 v4, 6, v4
    v_lshl_add_u32 v176, v5, 4, v4
    v_xor_b32 v5, 2, v5
    v_lshl_add_u32 v177, v5, 4, v4
    v_mov_b32 v178, v176
    v_mov_b32 v179, v177
    v_bfe_u32 v4, v2, 2, 1
    v_bfe_u32 v5, v2, 4, 1
    v_xor_b32 v4, v4, v5
    v_and_b32 v5, 3, v2
    v_or_b32 v4, v4, v5
    v_mov_b32 v5, 0x3f803f80
    v_cmp_eq_u32 vcc, 0, v4
    s_nop 1
    v_cndmask_b32 v172, 0, v5, vcc
    v_mov_b32 v173, v172
    v_mov_b32 v174, v172
    v_mov_b32 v175, v172
    s_lshl_b32 s47, s34, 2
    s_add_u32 s47, s47, s33
    s_lshl_b32 s47, s47, 6
    s_lshr_b32 s30, s58, 2
    s_lshl_b32 s31, s35, 1
    s_add_u32 s30, s30, s31
    s_lshl_b32 s30, s30, 1
    s_add_u32 s47, s47, s30
    s_lshl_b32 s47, s47, 10
    v_add_u32 v180, s47, v3
    v_mov_b32 v152, 0
    v_mov_b32 v153, 0
    v_mov_b32 v154, 0
    v_mov_b32 v155, 0
    v_mov_b32 v156, 0
    v_mov_b32 v157, 0
    v_mov_b32 v158, 0
    v_mov_b32 v159, 0
    v_mov_b32 v160, 0
    v_mov_b32 v161, 0
    v_mov_b32 v162, 0
    v_mov_b32 v163, 0
    v_mov_b32 v164, 0
    v_mov_b32 v165, 0
    v_mov_b32 v166, 0
    v_mov_b32 v167, 0
    v_mov_b32 v168, 0
    v_mov_b32 v169, 0
    v_mov_b32 v170, 0
    v_mov_b32 v171, 0
    s_and_b32 s30, s2, 3
    s_lshl_b32 s30, s30, 8
    s_lshl_b32 s31, s33, 6
    s_add_u32 s30, s30, s31
    s_mul_i32 s30, s30, 7168
    s_bfe_u32 s31, s2, 0x50002
    s_mul_i32 s31, s31, 224
    s_add_u32 s30, s30, s31
    v_add_u32 v5, 0, v2
    v_mul_u32_u24 v6, 4682, v5
    v_lshrrev_b32 v6, 16, v6
    v_mul_u32_u24 v7, 14, v6
    v_sub_u32 v7, v5, v7
    v_mul_u32_u24 v6, 7168, v6
    v_lshl_add_u32 v6, v7, 4, v6
    v_add_u32 v188, s30, v6
    v_add_u32 v5, 64, v2
    v_mul_u32_u24 v6, 4682, v5
    v_lshrrev_b32 v6, 16, v6
    v_mul_u32_u24 v7, 14, v6
    v_sub_u32 v7, v5, v7
    v_mul_u32_u24 v6, 7168, v6
    v_lshl_add_u32 v6, v7, 4, v6
    v_add_u32 v189, s30, v6
    v_add_u32 v5, 128, v2
    v_mul_u32_u24 v6, 4682, v5
    v_lshrrev_b32 v6, 16, v6
    v_mul_u32_u24 v7, 14, v6
    v_sub_u32 v7, v5, v7
    v_mul_u32_u24 v6, 7168, v6
    v_lshl_add_u32 v6, v7, 4, v6
    v_add_u32 v190, s30, v6
    v_add_u32 v5, 192, v2
    v_mul_u32_u24 v6, 4682, v5
    v_lshrrev_b32 v6, 16, v6
    v_mul_u32_u24 v7, 14, v6
    v_sub_u32 v7, v5, v7
    v_mul_u32_u24 v6, 7168, v6
    v_lshl_add_u32 v6, v7, 4, v6
    v_add_u32 v191, s30, v6
    v_add_u32 v5, 256, v2
    v_mul_u32_u24 v6, 4682, v5
    v_lshrrev_b32 v6, 16, v6
    v_mul_u32_u24 v7, 14, v6
    v_sub_u32 v7, v5, v7
    v_mul_u32_u24 v6, 7168, v6
    v_lshl_add_u32 v6, v7, 4, v6
    v_add_u32 v192, s30, v6
    v_add_u32 v5, 320, v2
    v_mul_u32_u24 v6, 4682, v5
    v_lshrrev_b32 v6, 16, v6
    v_mul_u32_u24 v7, 14, v6
    v_sub_u32 v7, v5, v7
    v_mul_u32_u24 v6, 7168, v6
    v_lshl_add_u32 v6, v7, 4, v6
    v_add_u32 v193, s30, v6
    v_add_u32 v5, 384, v2
    v_mul_u32_u24 v6, 4682, v5
    v_lshrrev_b32 v6, 16, v6
    v_mul_u32_u24 v7, 14, v6
    v_sub_u32 v7, v5, v7
    v_mul_u32_u24 v6, 7168, v6
    v_lshl_add_u32 v6, v7, 4, v6
    v_add_u32 v194, s30, v6
    s_mul_i32 s56, s33, 7168
    s_add_u32 s56, s56, 98304
    v_lshrrev_b32 v5, 2, v2
    v_mul_u32_u24 v5, 224, v5
    v_and_b32 v6, 3, v2
    v_lshl_add_u32 v5, v6, 3, v5
    v_add_u32 v181, s56, v5
    v_mov_b32 v184, 0x3f803f80
    v_mov_b32 v185, 0x3f803f80
    v_mov_b32 v186, 0x3f803f80
    v_mov_b32 v187, 0x3f803f80
    s_lshr_b32 s62, s2, 3
    s_lshl_b32 s62, s62, 16
    s_lshl_b32 s63, s33, 14
    s_add_u32 s62, s62, s63
    s_lshl_b32 s63, s2, 2
    s_add_u32 s63, s63, s33
    s_and_b32 s30, s63, 63
    s_mul_i32 s30, s30, 56
    s_lshr_b32 s31, s63, 6
    s_lshl_b32 s31, s31, 7
    s_mul_i32 s63, s63, 7168
    v_lshrrev_b32 v5, 3, v2
    v_add_u32 v5, s30, v5
    v_lshlrev_b32 v5, 11, v5
    v_add_u32 v5, s31, v5
    v_bfe_u32 v6, v2, 4, 1
    v_lshlrev_b32 v6, 2, v6
    v_and_b32 v7, 7, v2
    v_xor_b32 v6, v6, v7
    v_lshl_add_u32 v182, v6, 4, v5
    s_add_u32 s12, s28, 4194304
    s_addc_u32 s13, s29, 0
    s_mov_b32 s14, 262144
    s_mov_b32 s15, 0x20000
    s_add_u32 s16, s28, 5242880
    s_addc_u32 s17, s29, 0
    s_mov_b32 s18, 4194304
    s_mov_b32 s19, 0x20000
    s_cmp_ge_u32 s2, 128
    s_cselect_b32 s20, s22, s20
    s_cselect_b32 s21, s23, s21
    s_mov_b32 s22, 7340032
    s_mov_b32 s23, 0x20000
    s_mov_b32 s50, 2097152
    s_mov_b32 s51, 0x20000
    s_mov_b32 s54, 7340032
    s_mov_b32 s55, 0x20000
    s_add_u32 s72, s28, 33554432
    s_addc_u32 s73, s29, 0
    s_mov_b32 s74, 7340032
    s_mov_b32 s75, 0x20000
    s_add_u32 s24, s28, 14155776
    s_addc_u32 s25, s29, 0
    s_mov_b32 s26, 114688
    s_mov_b32 s27, 0x20000
    s_setprio 1
    s_barrier
    ds_read_b64_tr_b16 v[112:113], v14 offset:0
    ds_read_b64_tr_b16 v[114:115], v14 offset:512
    ds_read_b64_tr_b16 v[116:117], v15 offset:0
    ds_read_b64_tr_b16 v[118:119], v15 offset:512
    ds_read_b64_tr_b16 v[120:121], v14 offset:2048
    ds_read_b64_tr_b16 v[122:123], v14 offset:2560
    ds_read_b64_tr_b16 v[124:125], v15 offset:2048
    ds_read_b64_tr_b16 v[126:127], v15 offset:2560
    s_mov_b32 s39, 3
CS_k1_q_attn_kernel_26:
    s_waitcnt vmcnt(15) lgkmcnt(4)
    v_mfma_f32_32x32x16_bf16 v[16:31], v[112:115], v[48:51], v[16:31]
    ds_read_b64_tr_b16 v[128:129], v14 offset:4096
    ds_read_b64_tr_b16 v[130:131], v14 offset:4608
    v_mfma_f32_32x32x16_bf16 v[32:47], v[116:119], v[48:51], v[32:47]
    ds_read_b64_tr_b16 v[132:133], v15 offset:4096
    ds_read_b64_tr_b16 v[134:135], v15 offset:4608
    buffer_load_dwordx4 v[48:51], v10, s[4:7], s40 offen offset:0
    s_waitcnt vmcnt(15) lgkmcnt(4)
    v_mfma_f32_32x32x16_bf16 v[16:31], v[120:123], v[52:55], v[16:31]
    ds_read_b64_tr_b16 v[136:137], v14 offset:6144
    ds_read_b64_tr_b16 v[138:139], v14 offset:6656
    s_add_u32 s47, s43, 8192
    s_cmp_eq_u32 s47, 163840
    s_cselect_b32 s47, 98304, s47
    s_sub_u32 s44, s47, s43
    s_mov_b32 s43, s47
    v_mfma_f32_32x32x16_bf16 v[32:47], v[124:127], v[52:55], v[32:47]
    ds_read_b64_tr_b16 v[140:141], v15 offset:6144
    ds_read_b64_tr_b16 v[142:143], v15 offset:6656
    buffer_load_dwordx4 v[52:55], v10, s[4:7], s40 offen offset:1024
    s_barrier
    v_add_u32 v14, s44, v14
    v_add_u32 v15, s44, v15
    s_waitcnt vmcnt(15) lgkmcnt(4)
    v_mfma_f32_32x32x16_bf16 v[16:31], v[128:131], v[56:59], v[16:31]
    ds_read_b64_tr_b16 v[112:113], v14 offset:0
    ds_read_b64_tr_b16 v[114:115], v14 offset:512
    v_mfma_f32_32x32x16_bf16 v[32:47], v[132:135], v[56:59], v[32:47]
    ds_read_b64_tr_b16 v[116:117], v15 offset:0
    ds_read_b64_tr_b16 v[118:119], v15 offset:512
    buffer_load_dwordx4 v[56:59], v10, s[4:7], s40 offen offset:2048
    s_waitcnt vmcnt(15) lgkmcnt(4)
    v_mfma_f32_32x32x16_bf16 v[16:31], v[136:139], v[60:63], v[16:31]
    ds_read_b64_tr_b16 v[120:121], v14 offset:2048
    ds_read_b64_tr_b16 v[122:123], v14 offset:2560
    v_mfma_f32_32x32x16_bf16 v[32:47], v[140:143], v[60:63], v[32:47]
    ds_read_b64_tr_b16 v[124:125], v15 offset:2048
    ds_read_b64_tr_b16 v[126:127], v15 offset:2560
    buffer_load_dwordx4 v[60:63], v10, s[4:7], s40 offen offset:3072
    s_add_u32 s40, s40, 4096
    s_waitcnt vmcnt(15) lgkmcnt(4)
    v_mfma_f32_32x32x16_bf16 v[16:31], v[112:115], v[64:67], v[16:31]
    ds_read_b64_tr_b16 v[128:129], v14 offset:4096
    ds_read_b64_tr_b16 v[130:131], v14 offset:4608
    v_mfma_f32_32x32x16_bf16 v[32:47], v[116:119], v[64:67], v[32:47]
    ds_read_b64_tr_b16 v[132:133], v15 offset:4096
    ds_read_b64_tr_b16 v[134:135], v15 offset:4608
    buffer_load_dwordx4 v[64:67], v10, s[4:7], s40 offen offset:0
    s_waitcnt vmcnt(15) lgkmcnt(4)
    v_mfma_f32_32x32x16_bf16 v[16:31], v[120:123], v[68:71], v[16:31]
    ds_read_b64_tr_b16 v[136:137], v14 offset:6144
    ds_read_b64_tr_b16 v[138:139], v14 offset:6656
    s_add_u32 s47, s43, 8192
    s_cmp_eq_u32 s47, 163840
    s_cselect_b32 s47, 98304, s47
    s_sub_u32 s44, s47, s43
    s_mov_b32 s43, s47
    v_mfma_f32_32x32x16_bf16 v[32:47], v[124:127], v[68:71], v[32:47]
    ds_read_b64_tr_b16 v[140:141], v15 offset:6144
    ds_read_b64_tr_b16 v[142:143], v15 offset:6656
    buffer_load_dwordx4 v[68:71], v10, s[4:7], s40 offen offset:1024
    s_barrier
    v_add_u32 v14, s44, v14
    v_add_u32 v15, s44, v15
    s_waitcnt vmcnt(15) lgkmcnt(4)
    v_mfma_f32_32x32x16_bf16 v[16:31], v[128:131], v[72:75], v[16:31]
    ds_read_b64_tr_b16 v[112:113], v14 offset:0
    ds_read_b64_tr_b16 v[114:115], v14 offset:512
    v_mfma_f32_32x32x16_bf16 v[32:47], v[132:135], v[72:75], v[32:47]
    ds_read_b64_tr_b16 v[116:117], v15 offset:0
    ds_read_b64_tr_b16 v[118:119], v15 offset:512
    buffer_load_dwordx4 v[72:75], v10, s[4:7], s40 offen offset:2048
    s_waitcnt vmcnt(15) lgkmcnt(4)
    v_mfma_f32_32x32x16_bf16 v[16:31], v[136:139], v[76:79], v[16:31]
    ds_read_b64_tr_b16 v[120:121], v14 offset:2048
    ds_read_b64_tr_b16 v[122:123], v14 offset:2560
    v_mfma_f32_32x32x16_bf16 v[32:47], v[140:143], v[76:79], v[32:47]
    ds_read_b64_tr_b16 v[124:125], v15 offset:2048
    ds_read_b64_tr_b16 v[126:127], v15 offset:2560
    buffer_load_dwordx4 v[76:79], v10, s[4:7], s40 offen offset:3072
    s_add_u32 s40, s40, 4096
    s_waitcnt vmcnt(15) lgkmcnt(4)
    v_mfma_f32_32x32x16_bf16 v[16:31], v[112:115], v[80:83], v[16:31]
    ds_read_b64_tr_b16 v[128:129], v14 offset:4096
    ds_read_b64_tr_b16 v[130:131], v14 offset:4608
    v_mfma_f32_32x32x16_bf16 v[32:47], v[116:119], v[80:83], v[32:47]
    ds_read_b64_tr_b16 v[132:133], v15 offset:4096
    ds_read_b64_tr_b16 v[134:135], v15 offset:4608
    buffer_load_dwordx4 v[80:83], v10, s[4:7], s40 offen offset:0
    s_waitcnt vmcnt(15) lgkmcnt(4)
    v_mfma_f32_32x32x16_bf16 v[16:31], v[120:123], v[84:87], v[16:31]
    ds_read_b64_tr_b16 v[136:137], v14 offset:6144
    ds_read_b64_tr_b16 v[138:139], v14 offset:6656
    s_add_u32 s47, s43, 8192
    s_cmp_eq_u32 s47, 163840
    s_cselect_b32 s47, 98304, s47
    s_sub_u32 s44, s47, s43
    s_mov_b32 s43, s47
    v_mfma_f32_32x32x16_bf16 v[32:47], v[124:127], v[84:87], v[32:47]
    ds_read_b64_tr_b16 v[140:141], v15 offset:6144
    ds_read_b64_tr_b16 v[142:143], v15 offset:6656
    buffer_load_dwordx4 v[84:87], v10, s[4:7], s40 offen offset:1024
    s_barrier
    v_add_u32 v14, s44, v14
    v_add_u32 v15, s44, v15
    s_waitcnt vmcnt(15) lgkmcnt(4)
    v_mfma_f32_32x32x16_bf16 v[16:31], v[128:131], v[88:91], v[16:31]
    ds_read_b64_tr_b16 v[112:113], v14 offset:0
    ds_read_b64_tr_b16 v[114:115], v14 offset:512
    v_mfma_f32_32x32x16_bf16 v[32:47], v[132:135], v[88:91], v[32:47]
    ds_read_b64_tr_b16 v[116:117], v15 offset:0
    ds_read_b64_tr_b16 v[118:119], v15 offset:512
    buffer_load_dwordx4 v[88:91], v10, s[4:7], s40 offen offset:2048
    s_waitcnt vmcnt(15) lgkmcnt(4)
    v_mfma_f32_32x32x16_bf16 v[16:31], v[136:139], v[92:95], v[16:31]
    ds_read_b64_tr_b16 v[120:121], v14 offset:2048
    ds_read_b64_tr_b16 v[122:123], v14 offset:2560
    v_mfma_f32_32x32x16_bf16 v[32:47], v[140:143], v[92:95], v[32:47]
    ds_read_b64_tr_b16 v[124:125], v15 offset:2048
    ds_read_b64_tr_b16 v[126:127], v15 offset:2560
    buffer_load_dwordx4 v[92:95], v10, s[4:7], s40 offen offset:3072
    s_add_u32 s40, s40, 4096
    s_waitcnt vmcnt(15) lgkmcnt(4)
    v_mfma_f32_32x32x16_bf16 v[16:31], v[112:115], v[96:99], v[16:31]
    ds_read_b64_tr_b16 v[128:129], v14 offset:4096
    ds_read_b64_tr_b16 v[130:131], v14 offset:4608
    v_mfma_f32_32x32x16_bf16 v[32:47], v[116:119], v[96:99], v[32:47]
    ds_read_b64_tr_b16 v[132:133], v15 offset:4096
    ds_read_b64_tr_b16 v[134:135], v15 offset:4608
    buffer_load_dwordx4 v[96:99], v10, s[4:7], s40 offen offset:0
    s_waitcnt vmcnt(15) lgkmcnt(4)
    v_mfma_f32_32x32x16_bf16 v[16:31], v[120:123], v[100:103], v[16:31]
    ds_read_b64_tr_b16 v[136:137], v14 offset:6144
    ds_read_b64_tr_b16 v[138:139], v14 offset:6656
    s_add_u32 s47, s43, 8192
    s_cmp_eq_u32 s47, 163840
    s_cselect_b32 s47, 98304, s47
    s_sub_u32 s44, s47, s43
    s_mov_b32 s43, s47
    v_mfma_f32_32x32x16_bf16 v[32:47], v[124:127], v[100:103], v[32:47]
    ds_read_b64_tr_b16 v[140:141], v15 offset:6144
    ds_read_b64_tr_b16 v[142:143], v15 offset:6656
    buffer_load_dwordx4 v[100:103], v10, s[4:7], s40 offen offset:1024
    s_barrier
    v_add_u32 v14, s44, v14
    v_add_u32 v15, s44, v15
    s_waitcnt vmcnt(15) lgkmcnt(4)
    v_mfma_f32_32x32x16_bf16 v[16:31], v[128:131], v[104:107], v[16:31]
    ds_read_b64_tr_b16 v[112:113], v14 offset:0
    ds_read_b64_tr_b16 v[114:115], v14 offset:512
    v_mfma_f32_32x32x16_bf16 v[32:47], v[132:135], v[104:107], v[32:47]
    ds_read_b64_tr_b16 v[116:117], v15 offset:0
    ds_read_b64_tr_b16 v[118:119], v15 offset:512
    buffer_load_dwordx4 v[104:107], v10, s[4:7], s40 offen offset:2048
    s_waitcnt vmcnt(15) lgkmcnt(4)
    v_mfma_f32_32x32x16_bf16 v[16:31], v[136:139], v[108:111], v[16:31]
    ds_read_b64_tr_b16 v[120:121], v14 offset:2048
    ds_read_b64_tr_b16 v[122:123], v14 offset:2560
    v_mfma_f32_32x32x16_bf16 v[32:47], v[140:143], v[108:111], v[32:47]
    ds_read_b64_tr_b16 v[124:125], v15 offset:2048
    ds_read_b64_tr_b16 v[126:127], v15 offset:2560
    buffer_load_dwordx4 v[108:111], v10, s[4:7], s40 offen offset:3072
    s_add_u32 s40, s40, 4096
    s_sub_u32 s39, s39, 1
    s_cmp_lg_u32 s39, 0
    s_cbranch_scc1 CS_k1_q_attn_kernel_26
    s_waitcnt vmcnt(15) lgkmcnt(4)
    v_mfma_f32_32x32x16_bf16 v[16:31], v[112:115], v[48:51], v[16:31]
    ds_read_b64_tr_b16 v[128:129], v14 offset:4096
    ds_read_b64_tr_b16 v[130:131], v14 offset:4608
    v_mfma_f32_32x32x16_bf16 v[32:47], v[116:119], v[48:51], v[32:47]
    ds_read_b64_tr_b16 v[132:133], v15 offset:4096
    ds_read_b64_tr_b16 v[134:135], v15 offset:4608
    s_waitcnt vmcnt(14) lgkmcnt(4)
    v_mfma_f32_32x32x16_bf16 v[16:31], v[120:123], v[52:55], v[16:31]
    ds_read_b64_tr_b16 v[136:137], v14 offset:6144
    ds_read_b64_tr_b16 v[138:139], v14 offset:6656
    s_add_u32 s47, s43, 8192
    s_cmp_eq_u32 s47, 163840
    s_cselect_b32 s47, 98304, s47
    s_sub_u32 s44, s47, s43
    s_mov_b32 s43, s47
    v_mfma_f32_32x32x16_bf16 v[32:47], v[124:127], v[52:55], v[32:47]
    ds_read_b64_tr_b16 v[140:141], v15 offset:6144
    ds_read_b64_tr_b16 v[142:143], v15 offset:6656
    s_barrier
    v_add_u32 v14, s44, v14
    v_add_u32 v15, s44, v15
    s_waitcnt vmcnt(13) lgkmcnt(4)
    v_mfma_f32_32x32x16_bf16 v[16:31], v[128:131], v[56:59], v[16:31]
    ds_read_b64_tr_b16 v[112:113], v14 offset:0
    ds_read_b64_tr_b16 v[114:115], v14 offset:512
    v_mfma_f32_32x32x16_bf16 v[32:47], v[132:135], v[56:59], v[32:47]
    ds_read_b64_tr_b16 v[116:117], v15 offset:0
    ds_read_b64_tr_b16 v[118:119], v15 offset:512
    s_waitcnt vmcnt(12) lgkmcnt(4)
    v_mfma_f32_32x32x16_bf16 v[16:31], v[136:139], v[60:63], v[16:31]
    ds_read_b64_tr_b16 v[120:121], v14 offset:2048
    ds_read_b64_tr_b16 v[122:123], v14 offset:2560
    v_mfma_f32_32x32x16_bf16 v[32:47], v[140:143], v[60:63], v[32:47]
    ds_read_b64_tr_b16 v[124:125], v15 offset:2048
    ds_read_b64_tr_b16 v[126:127], v15 offset:2560
    s_waitcnt vmcnt(11) lgkmcnt(4)
    v_mfma_f32_32x32x16_bf16 v[16:31], v[112:115], v[64:67], v[16:31]
    ds_read_b64_tr_b16 v[128:129], v14 offset:4096
    ds_read_b64_tr_b16 v[130:131], v14 offset:4608
    v_mfma_f32_32x32x16_bf16 v[32:47], v[116:119], v[64:67], v[32:47]
    ds_read_b64_tr_b16 v[132:133], v15 offset:4096
    ds_read_b64_tr_b16 v[134:135], v15 offset:4608
    s_waitcnt vmcnt(10) lgkmcnt(4)
    v_mfma_f32_32x32x16_bf16 v[16:31], v[120:123], v[68:71], v[16:31]
    ds_read_b64_tr_b16 v[136:137], v14 offset:6144
    ds_read_b64_tr_b16 v[138:139], v14 offset:6656
    s_add_u32 s47, s43, 8192
    s_cmp_eq_u32 s47, 163840
    s_cselect_b32 s47, 98304, s47
    s_sub_u32 s44, s47, s43
    s_mov_b32 s43, s47
    v_mfma_f32_32x32x16_bf16 v[32:47], v[124:127], v[68:71], v[32:47]
    ds_read_b64_tr_b16 v[140:141], v15 offset:6144
    ds_read_b64_tr_b16 v[142:143], v15 offset:6656
    s_barrier
    v_add_u32 v14, s44, v14
    v_add_u32 v15, s44, v15
    s_waitcnt vmcnt(9) lgkmcnt(4)
    v_mfma_f32_32x32x16_bf16 v[16:31], v[128:131], v[72:75], v[16:31]
    ds_read_b64_tr_b16 v[112:113], v14 offset:0
    ds_read_b64_tr_b16 v[114:115], v14 offset:512
    v_mfma_f32_32x32x16_bf16 v[32:47], v[132:135], v[72:75], v[32:47]
    ds_read_b64_tr_b16 v[116:117], v15 offset:0
    ds_read_b64_tr_b16 v[118:119], v15 offset:512
    s_waitcnt vmcnt(8) lgkmcnt(4)
    v_mfma_f32_32x32x16_bf16 v[16:31], v[136:139], v[76:79], v[16:31]
    ds_read_b64_tr_b16 v[120:121], v14 offset:2048
    ds_read_b64_tr_b16 v[122:123], v14 offset:2560
    v_mfma_f32_32x32x16_bf16 v[32:47], v[140:143], v[76:79], v[32:47]
    ds_read_b64_tr_b16 v[124:125], v15 offset:2048
    ds_read_b64_tr_b16 v[126:127], v15 offset:2560
    s_waitcnt vmcnt(7) lgkmcnt(4)
    v_mfma_f32_32x32x16_bf16 v[16:31], v[112:115], v[80:83], v[16:31]
    ds_read_b64_tr_b16 v[128:129], v14 offset:4096
    ds_read_b64_tr_b16 v[130:131], v14 offset:4608
    v_mfma_f32_32x32x16_bf16 v[32:47], v[116:119], v[80:83], v[32:47]
    ds_read_b64_tr_b16 v[132:133], v15 offset:4096
    ds_read_b64_tr_b16 v[134:135], v15 offset:4608
    s_waitcnt vmcnt(6) lgkmcnt(4)
    v_mfma_f32_32x32x16_bf16 v[16:31], v[120:123], v[84:87], v[16:31]
    ds_read_b64_tr_b16 v[136:137], v14 offset:6144
    ds_read_b64_tr_b16 v[138:139], v14 offset:6656
    s_add_u32 s47, s43, 8192
    s_cmp_eq_u32 s47, 163840
    s_cselect_b32 s47, 98304, s47
    s_sub_u32 s44, s47, s43
    s_mov_b32 s43, s47
    v_mfma_f32_32x32x16_bf16 v[32:47], v[124:127], v[84:87], v[32:47]
    ds_read_b64_tr_b16 v[140:141], v15 offset:6144
    ds_read_b64_tr_b16 v[142:143], v15 offset:6656
    s_barrier
    v_add_u32 v14, s44, v14
    v_add_u32 v15, s44, v15
    s_waitcnt vmcnt(5) lgkmcnt(4)
    v_mfma_f32_32x32x16_bf16 v[16:31], v[128:131], v[88:91], v[16:31]
    ds_read_b64_tr_b16 v[112:113], v14 offset:0
    ds_read_b64_tr_b16 v[114:115], v14 offset:512
    v_mfma_f32_32x32x16_bf16 v[32:47], v[132:135], v[88:91], v[32:47]
    ds_read_b64_tr_b16 v[116:117], v15 offset:0
    ds_read_b64_tr_b16 v[118:119], v15 offset:512
    s_waitcnt vmcnt(4) lgkmcnt(4)
    v_mfma_f32_32x32x16_bf16 v[16:31], v[136:139], v[92:95], v[16:31]
    ds_read_b64_tr_b16 v[120:121], v14 offset:2048
    ds_read_b64_tr_b16 v[122:123], v14 offset:2560
    v_mfma_f32_32x32x16_bf16 v[32:47], v[140:143], v[92:95], v[32:47]
    ds_read_b64_tr_b16 v[124:125], v15 offset:2048
    ds_read_b64_tr_b16 v[126:127], v15 offset:2560
    s_waitcnt vmcnt(3) lgkmcnt(4)
    v_mfma_f32_32x32x16_bf16 v[16:31], v[112:115], v[96:99], v[16:31]
    ds_read_b64_tr_b16 v[128:129], v14 offset:4096
    ds_read_b64_tr_b16 v[130:131], v14 offset:4608
    v_mfma_f32_32x32x16_bf16 v[32:47], v[116:119], v[96:99], v[32:47]
    ds_read_b64_tr_b16 v[132:133], v15 offset:4096
    ds_read_b64_tr_b16 v[134:135], v15 offset:4608
    s_waitcnt vmcnt(2) lgkmcnt(4)
    v_mfma_f32_32x32x16_bf16 v[16:31], v[120:123], v[100:103], v[16:31]
    ds_read_b64_tr_b16 v[136:137], v14 offset:6144
    ds_read_b64_tr_b16 v[138:139], v14 offset:6656
    v_mfma_f32_32x32x16_bf16 v[32:47], v[124:127], v[100:103], v[32:47]
    ds_read_b64_tr_b16 v[140:141], v15 offset:6144
    ds_read_b64_tr_b16 v[142:143], v15 offset:6656
    s_waitcnt vmcnt(1) lgkmcnt(4)
    v_mfma_f32_32x32x16_bf16 v[16:31], v[128:131], v[104:107], v[16:31]
    v_mfma_f32_32x32x16_bf16 v[32:47], v[132:135], v[104:107], v[32:47]
    s_waitcnt vmcnt(0) lgkmcnt(0)
    v_mfma_f32_32x32x16_bf16 v[16:31], v[136:139], v[108:111], v[16:31]
    v_mfma_f32_32x32x16_bf16 v[32:47], v[140:143], v[108:111], v[32:47]
    s_setprio 0
    v_mov_b32 v60, 0x3e8293ee
    s_nop 11
    v_mul_f32 v16, v16, v60
    v_mul_f32 v17, v17, v60
    v_mul_f32 v18, v18, v60
    v_mul_f32 v19, v19, v60
    v_mul_f32 v20, v20, v60
    v_mul_f32 v21, v21, v60
    v_mul_f32 v22, v22, v60
    v_mul_f32 v23, v23, v60
    v_mul_f32 v24, v24, v60
    v_mul_f32 v25, v25, v60
    v_mul_f32 v26, v26, v60
    v_mul_f32 v27, v27, v60
    v_mul_f32 v28, v28, v60
    v_mul_f32 v29, v29, v60
    v_mul_f32 v30, v30, v60
    v_mul_f32 v31, v31, v60
    v_mul_f32 v32, v32, v60
    v_mul_f32 v33, v33, v60
    v_mul_f32 v34, v34, v60
    v_mul_f32 v35, v35, v60
    v_mul_f32 v36, v36, v60
    v_mul_f32 v37, v37, v60
    v_mul_f32 v38, v38, v60
    v_mul_f32 v39, v39, v60
    v_mul_f32 v40, v40, v60
    v_mul_f32 v41, v41, v60
    v_mul_f32 v42, v42, v60
    v_mul_f32 v43, v43, v60
    v_mul_f32 v44, v44, v60
    v_mul_f32 v45, v45, v60
    v_mul_f32 v46, v46, v60
    v_mul_f32 v47, v47, v60
    v_cvt_pk_bf16_f32 v144, v16, v17
    v_cvt_pk_bf16_f32 v145, v18, v19
    v_cvt_pk_bf16_f32 v146, v20, v21
    v_cvt_pk_bf16_f32 v147, v22, v23
    v_cvt_pk_bf16_f32 v148, v24, v25
    v_cvt_pk_bf16_f32 v149, v26, v27
    v_cvt_pk_bf16_f32 v150, v28, v29
    v_cvt_pk_bf16_f32 v151, v30, v31
    v_cvt_pk_bf16_f32 v64, v32, v33
    v_cvt_pk_bf16_f32 v65, v34, v35
    v_cvt_pk_bf16_f32 v66, v36, v37
    v_cvt_pk_bf16_f32 v67, v38, v39
    v_cvt_pk_bf16_f32 v68, v40, v41
    v_cvt_pk_bf16_f32 v69, v42, v43
    v_cvt_pk_bf16_f32 v70, v44, v45
    v_cvt_pk_bf16_f32 v71, v46, v47
    s_lshl_b32 s47, s33, 11
    s_add_u32 s47, s47, 65536
    v_add_u32 v4, s47, v3
    ds_write_b128 v4, v[64:67]
    ds_write_b128 v4, v[68:71] offset:1024
    s_waitcnt lgkmcnt(0)
    s_barrier
JOIN_k1_q_attn_kernel_24:
    ds_read_b128 v[80:83], v176 offset:0
    ds_read_b128 v[84:87], v177 offset:0
    ds_read_b128 v[88:91], v178 offset:2048
    v_mov_b32 v100, 0
    v_mov_b32 v92, 0
    v_mov_b32 v101, 0
    v_mov_b32 v93, 0
    v_mov_b32 v102, 0
    v_mov_b32 v94, 0
    v_mov_b32 v103, 0
    v_mov_b32 v95, 0
    s_waitcnt lgkmcnt(0)
    v_mfma_f32_32x32x16_bf16 v[48:63], v[80:83], v[144:147], 0
    v_mfma_f32_32x32x16_bf16 v[48:63], v[84:87], v[148:151], v[48:63]
    ds_read_b128 v[80:83], v176 offset:4096
    ds_read_b128 v[84:87], v177 offset:4096
    s_waitcnt lgkmcnt(0)
    s_nop 9
    s_mov_b32 s39, 0
    s_mov_b32 s60, 0
    s_branch T0_k1_q_attn_kernel_27
T6_k1_q_attn_kernel_28:
    v_add_u32 v176, s59, v176
    v_add_u32 v177, s59, v177
    s_waitcnt lgkmcnt(3)
    v_exp_f32 v48, v48
    v_exp_f32 v49, v49
    v_mfma_f32_32x32x16_bf16 v[152:167], v[92:95], v[100:103], v[152:167]
    ds_read_b128 v[92:95], v179 offset:26624
    v_exp_f32 v50, v50
    v_exp_f32 v51, v51
    v_cvt_pk_bf16_f32 v96, v48, v49
    v_exp_f32 v52, v52
    s_waitcnt lgkmcnt(2)
    v_mfma_f32_32x32x16_bf16 v[64:79], v[80:83], v[144:147], 0
    v_exp_f32 v53, v53
    v_cvt_pk_bf16_f32 v97, v50, v51
    v_exp_f32 v54, v54
    v_exp_f32 v55, v55
    v_mfma_f32_16x16x32_bf16 v[168:171], v[172:175], v[100:103], v[168:171]
    v_cvt_pk_bf16_f32 v98, v52, v53
    v_exp_f32 v56, v56
    v_mfma_f32_32x32x16_bf16 v[64:79], v[84:87], v[148:151], v[64:79]
    ds_read_b128 v[80:83], v176 offset:0
    ds_read_b128 v[84:87], v177 offset:0
    v_cvt_pk_bf16_f32 v99, v54, v55
    v_exp_f32 v57, v57
    v_exp_f32 v58, v58
    v_exp_f32 v59, v59
    s_waitcnt lgkmcnt(3)
    v_mfma_f32_32x32x16_bf16 v[152:167], v[88:91], v[96:99], v[152:167]
    ds_read_b128 v[88:91], v178 offset:30720
    v_cvt_pk_bf16_f32 v100, v56, v57
    v_exp_f32 v60, v60
    v_exp_f32 v61, v61
    v_cvt_pk_bf16_f32 v101, v58, v59
    v_mfma_f32_16x16x32_bf16 v[168:171], v[172:175], v[96:99], v[168:171]
    v_exp_f32 v62, v62
    v_exp_f32 v63, v63
    v_cvt_pk_bf16_f32 v102, v60, v61
    v_cvt_pk_bf16_f32 v103, v62, v63
    v_add_u32 v178, s59, v178
    s_waitcnt lgkmcnt(3)
    v_exp_f32 v64, v64
    v_exp_f32 v65, v65
    v_mfma_f32_32x32x16_bf16 v[152:167], v[92:95], v[100:103], v[152:167]
    ds_read_b128 v[92:95], v179 offset:30720
    v_exp_f32 v66, v66
    v_exp_f32 v67, v67
    v_cvt_pk_bf16_f32 v96, v64, v65
    v_exp_f32 v68, v68
    s_waitcnt lgkmcnt(2)
    v_mfma_f32_32x32x16_bf16 v[48:63], v[80:83], v[144:147], 0
    v_exp_f32 v69, v69
    v_cvt_pk_bf16_f32 v97, v66, v67
    v_exp_f32 v70, v70
    v_exp_f32 v71, v71
    v_mfma_f32_16x16x32_bf16 v[168:171], v[172:175], v[100:103], v[168:171]
    v_cvt_pk_bf16_f32 v98, v68, v69
    v_exp_f32 v72, v72
    v_mfma_f32_32x32x16_bf16 v[48:63], v[84:87], v[148:151], v[48:63]
    ds_read_b128 v[80:83], v176 offset:4096
    ds_read_b128 v[84:87], v177 offset:4096
    v_cvt_pk_bf16_f32 v99, v70, v71
    v_exp_f32 v73, v73
    v_exp_f32 v74, v74
    v_exp_f32 v75, v75
    s_waitcnt lgkmcnt(3)
    v_mfma_f32_32x32x16_bf16 v[152:167], v[88:91], v[96:99], v[152:167]
    ds_read_b128 v[88:91], v178 offset:2048
    v_cvt_pk_bf16_f32 v100, v72, v73
    v_exp_f32 v76, v76
    v_exp_f32 v77, v77
    v_cvt_pk_bf16_f32 v101, v74, v75
    v_mfma_f32_16x16x32_bf16 v[168:171], v[172:175], v[96:99], v[168:171]
    v_exp_f32 v78, v78
    v_exp_f32 v79, v79
    v_cvt_pk_bf16_f32 v102, v76, v77
    v_cvt_pk_bf16_f32 v103, v78, v79
    v_add_u32 v179, s59, v179
    s_cmp_eq_u32 s39, 8
    s_cbranch_scc1 X_k1_q_attn_kernel_12
T0_k1_q_attn_kernel_27:
    s_waitcnt lgkmcnt(3)
    v_exp_f32 v48, v48
    v_exp_f32 v49, v49
    v_mfma_f32_32x32x16_bf16 v[152:167], v[92:95], v[100:103], v[152:167]
    ds_read_b128 v[92:95], v179 offset:2048
    v_exp_f32 v50, v50
    v_exp_f32 v51, v51
    v_cvt_pk_bf16_f32 v96, v48, v49
    v_exp_f32 v52, v52
    s_waitcnt lgkmcnt(2)
    v_mfma_f32_32x32x16_bf16 v[64:79], v[80:83], v[144:147], 0
    v_exp_f32 v53, v53
    v_cvt_pk_bf16_f32 v97, v50, v51
    v_exp_f32 v54, v54
    v_exp_f32 v55, v55
    v_mfma_f32_16x16x32_bf16 v[168:171], v[172:175], v[100:103], v[168:171]
    v_cvt_pk_bf16_f32 v98, v52, v53
    v_exp_f32 v56, v56
    v_mfma_f32_32x32x16_bf16 v[64:79], v[84:87], v[148:151], v[64:79]
    ds_read_b128 v[80:83], v176 offset:8192
    ds_read_b128 v[84:87], v177 offset:8192
    v_cvt_pk_bf16_f32 v99, v54, v55
    v_exp_f32 v57, v57
    v_exp_f32 v58, v58
    v_exp_f32 v59, v59
    s_waitcnt lgkmcnt(3)
    v_mfma_f32_32x32x16_bf16 v[152:167], v[88:91], v[96:99], v[152:167]
    ds_read_b128 v[88:91], v178 offset:6144
    v_cvt_pk_bf16_f32 v100, v56, v57
    v_exp_f32 v60, v60
    v_exp_f32 v61, v61
    v_cvt_pk_bf16_f32 v101, v58, v59
    v_mfma_f32_16x16x32_bf16 v[168:171], v[172:175], v[96:99], v[168:171]
    v_exp_f32 v62, v62
    v_exp_f32 v63, v63
    v_cvt_pk_bf16_f32 v102, v60, v61
    v_cvt_pk_bf16_f32 v103, v62, v63
    s_waitcnt lgkmcnt(3)
    v_exp_f32 v64, v64
    v_exp_f32 v65, v65
    v_mfma_f32_32x32x16_bf16 v[152:167], v[92:95], v[100:103], v[152:167]
    ds_read_b128 v[92:95], v179 offset:6144
    v_exp_f32 v66, v66
    v_exp_f32 v67, v67
    v_cvt_pk_bf16_f32 v96, v64, v65
    v_exp_f32 v68, v68
    s_waitcnt lgkmcnt(2)
    v_mfma_f32_32x32x16_bf16 v[48:63], v[80:83], v[144:147], 0
    v_exp_f32 v69, v69
    v_cvt_pk_bf16_f32 v97, v66, v67
    v_exp_f32 v70, v70
    v_exp_f32 v71, v71
    v_mfma_f32_16x16x32_bf16 v[168:171], v[172:175], v[100:103], v[168:171]
    v_cvt_pk_bf16_f32 v98, v68, v69
    v_exp_f32 v72, v72
    v_mfma_f32_32x32x16_bf16 v[48:63], v[84:87], v[148:151], v[48:63]
    ds_read_b128 v[80:83], v176 offset:12288
    ds_read_b128 v[84:87], v177 offset:12288
    v_cvt_pk_bf16_f32 v99, v70, v71
    v_exp_f32 v73, v73
    v_exp_f32 v74, v74
    v_exp_f32 v75, v75
    s_waitcnt lgkmcnt(3)
    v_mfma_f32_32x32x16_bf16 v[152:167], v[88:91], v[96:99], v[152:167]
    ds_read_b128 v[88:91], v178 offset:10240
    v_cvt_pk_bf16_f32 v100, v72, v73
    v_exp_f32 v76, v76
    v_exp_f32 v77, v77
    v_cvt_pk_bf16_f32 v101, v74, v75
    v_mfma_f32_16x16x32_bf16 v[168:171], v[172:175], v[96:99], v[168:171]
    v_exp_f32 v78, v78
    v_exp_f32 v79, v79
    v_cvt_pk_bf16_f32 v102, v76, v77
    v_cvt_pk_bf16_f32 v103, v78, v79
    s_cmp_lt_u32 s58, 4
    s_cbranch_scc1 MD_k1_q_attn_kernel_10
MR_k1_q_attn_kernel_29:
    s_waitcnt lgkmcnt(3)
    v_exp_f32 v48, v48
    v_exp_f32 v49, v49
    v_mfma_f32_32x32x16_bf16 v[152:167], v[92:95], v[100:103], v[152:167]
    ds_read_b128 v[92:95], v179 offset:10240
    v_exp_f32 v50, v50
    v_exp_f32 v51, v51
    v_cvt_pk_bf16_f32 v96, v48, v49
    v_exp_f32 v52, v52
    s_waitcnt lgkmcnt(2)
    v_mfma_f32_32x32x16_bf16 v[64:79], v[80:83], v[144:147], 0
    v_exp_f32 v53, v53
    v_cvt_pk_bf16_f32 v97, v50, v51
    v_exp_f32 v54, v54
    v_exp_f32 v55, v55
    v_mfma_f32_16x16x32_bf16 v[168:171], v[172:175], v[100:103], v[168:171]
    v_cvt_pk_bf16_f32 v98, v52, v53
    v_exp_f32 v56, v56
    v_mfma_f32_32x32x16_bf16 v[64:79], v[84:87], v[148:151], v[64:79]
    ds_read_b128 v[80:83], v176 offset:16384
    ds_read_b128 v[84:87], v177 offset:16384
    v_cvt_pk_bf16_f32 v99, v54, v55
    v_exp_f32 v57, v57
    v_exp_f32 v58, v58
    v_exp_f32 v59, v59
    s_waitcnt lgkmcnt(3)
    v_mfma_f32_32x32x16_bf16 v[152:167], v[88:91], v[96:99], v[152:167]
    ds_read_b128 v[88:91], v178 offset:14336
    v_cvt_pk_bf16_f32 v100, v56, v57
    v_exp_f32 v60, v60
    v_exp_f32 v61, v61
    v_cvt_pk_bf16_f32 v101, v58, v59
    v_mfma_f32_16x16x32_bf16 v[168:171], v[172:175], v[96:99], v[168:171]
    v_exp_f32 v62, v62
    v_exp_f32 v63, v63
    v_cvt_pk_bf16_f32 v102, v60, v61
    v_cvt_pk_bf16_f32 v103, v62, v63
    s_waitcnt lgkmcnt(3)
    v_exp_f32 v64, v64
    v_exp_f32 v65, v65
    v_mfma_f32_32x32x16_bf16 v[152:167], v[92:95], v[100:103], v[152:167]
    ds_read_b128 v[92:95], v179 offset:14336
    v_exp_f32 v66, v66
    v_exp_f32 v67, v67
    v_cvt_pk_bf16_f32 v96, v64, v65
    v_exp_f32 v68, v68
    s_waitcnt lgkmcnt(2)
    v_mfma_f32_32x32x16_bf16 v[48:63], v[80:83], v[144:147], 0
    v_exp_f32 v69, v69
    v_cvt_pk_bf16_f32 v97, v66, v67
    v_exp_f32 v70, v70
    v_exp_f32 v71, v71
    v_mfma_f32_16x16x32_bf16 v[168:171], v[172:175], v[100:103], v[168:171]
    v_cvt_pk_bf16_f32 v98, v68, v69
    v_exp_f32 v72, v72
    v_mfma_f32_32x32x16_bf16 v[48:63], v[84:87], v[148:151], v[48:63]
    ds_read_b128 v[80:83], v176 offset:20480
    ds_read_b128 v[84:87], v177 offset:20480
    v_cvt_pk_bf16_f32 v99, v70, v71
    v_exp_f32 v73, v73
    v_exp_f32 v74, v74
    v_exp_f32 v75, v75
    s_waitcnt lgkmcnt(3)
    v_mfma_f32_32x32x16_bf16 v[152:167], v[88:91], v[96:99], v[152:167]
    ds_read_b128 v[88:91], v178 offset:18432
    v_cvt_pk_bf16_f32 v100, v72, v73
    v_exp_f32 v76, v76
    v_exp_f32 v77, v77
    v_cvt_pk_bf16_f32 v101, v74, v75
    v_mfma_f32_16x16x32_bf16 v[168:171], v[172:175], v[96:99], v[168:171]
    v_exp_f32 v78, v78
    v_exp_f32 v79, v79
    v_cvt_pk_bf16_f32 v102, v76, v77
    v_cvt_pk_bf16_f32 v103, v78, v79
    s_waitcnt lgkmcnt(3)
    v_exp_f32 v48, v48
    v_exp_f32 v49, v49
    v_mfma_f32_32x32x16_bf16 v[152:167], v[92:95], v[100:103], v[152:167]
    ds_read_b128 v[92:95], v179 offset:18432
    v_exp_f32 v50, v50
    v_exp_f32 v51, v51
    v_cvt_pk_bf16_f32 v96, v48, v49
    v_exp_f32 v52, v52
    s_waitcnt lgkmcnt(2)
    v_mfma_f32_32x32x16_bf16 v[64:79], v[80:83], v[144:147], 0
    v_exp_f32 v53, v53
    v_cvt_pk_bf16_f32 v97, v50, v51
    v_exp_f32 v54, v54
    v_exp_f32 v55, v55
    v_mfma_f32_16x16x32_bf16 v[168:171], v[172:175], v[100:103], v[168:171]
    v_cvt_pk_bf16_f32 v98, v52, v53
    v_exp_f32 v56, v56
    v_mfma_f32_32x32x16_bf16 v[64:79], v[84:87], v[148:151], v[64:79]
    ds_read_b128 v[80:83], v176 offset:24576
    ds_read_b128 v[84:87], v177 offset:24576
    v_cvt_pk_bf16_f32 v99, v54, v55
    v_exp_f32 v57, v57
    v_exp_f32 v58, v58
    v_exp_f32 v59, v59
    s_waitcnt lgkmcnt(3)
    v_mfma_f32_32x32x16_bf16 v[152:167], v[88:91], v[96:99], v[152:167]
    ds_read_b128 v[88:91], v178 offset:22528
    v_cvt_pk_bf16_f32 v100, v56, v57
    v_exp_f32 v60, v60
    v_exp_f32 v61, v61
    v_cvt_pk_bf16_f32 v101, v58, v59
    v_mfma_f32_16x16x32_bf16 v[168:171], v[172:175], v[96:99], v[168:171]
    v_exp_f32 v62, v62
    v_exp_f32 v63, v63
    v_cvt_pk_bf16_f32 v102, v60, v61
    v_cvt_pk_bf16_f32 v103, v62, v63
    s_waitcnt lgkmcnt(3)
    v_exp_f32 v64, v64
    v_exp_f32 v65, v65
    v_mfma_f32_32x32x16_bf16 v[152:167], v[92:95], v[100:103], v[152:167]
    ds_read_b128 v[92:95], v179 offset:22528
    v_exp_f32 v66, v66
    v_exp_f32 v67, v67
    v_cvt_pk_bf16_f32 v96, v64, v65
    v_exp_f32 v68, v68
    s_waitcnt lgkmcnt(2)
    v_mfma_f32_32x32x16_bf16 v[48:63], v[80:83], v[144:147], 0
    v_exp_f32 v69, v69
    v_cvt_pk_bf16_f32 v97, v66, v67
    v_exp_f32 v70, v70
    v_exp_f32 v71, v71
    v_mfma_f32_16x16x32_bf16 v[168:171], v[172:175], v[100:103], v[168:171]
    v_cvt_pk_bf16_f32 v98, v68, v69
    v_exp_f32 v72, v72
    v_mfma_f32_32x32x16_bf16 v[48:63], v[84:87], v[148:151], v[48:63]
    ds_read_b128 v[80:83], v176 offset:28672
    ds_read_b128 v[84:87], v177 offset:28672
    v_cvt_pk_bf16_f32 v99, v70, v71
    v_exp_f32 v73, v73
    v_exp_f32 v74, v74
    v_exp_f32 v75, v75
    s_waitcnt lgkmcnt(3)
    v_mfma_f32_32x32x16_bf16 v[152:167], v[88:91], v[96:99], v[152:167]
    ds_read_b128 v[88:91], v178 offset:26624
    v_cvt_pk_bf16_f32 v100, v72, v73
    v_exp_f32 v76, v76
    v_exp_f32 v77, v77
    v_cvt_pk_bf16_f32 v101, v74, v75
    v_mfma_f32_16x16x32_bf16 v[168:171], v[172:175], v[96:99], v[168:171]
    v_exp_f32 v78, v78
    v_exp_f32 v79, v79
    v_cvt_pk_bf16_f32 v102, v76, v77
    v_cvt_pk_bf16_f32 v103, v78, v79
    s_mov_b32 s59, 0xffff0000
    s_cmp_eq_u32 s60, 2
    s_cselect_b32 s59, s59, 0x8000
    s_add_u32 s61, s60, 2
    s_add_u32 s60, s60, 1
    s_cmp_eq_u32 s60, 3
    s_cselect_b32 s60, 0, s60
    s_cmp_ge_u32 s58, 4
    s_cbranch_scc1 G1_k1_q_attn_kernel_11
    s_cmp_eq_u32 s39, 7
    s_cbranch_scc1 NB_k1_q_attn_kernel_30
    s_barrier
NB_k1_q_attn_kernel_30:
    s_add_u32 s39, s39, 1
    s_branch T6_k1_q_attn_kernel_28
G1_k1_q_attn_kernel_11:
    s_cmp_eq_u32 s39, 7
    s_cbranch_scc1 G1c_k1_q_attn_kernel_31
    s_waitcnt vmcnt(0)
    s_barrier
    s_cmp_ge_u32 s39, 6
    s_cbranch_scc1 G1c_k1_q_attn_kernel_31
    s_add_u32 s30, s39, 2
    s_lshl_b32 s31, s30, 15
    s_sub_u32 s30, s61, 3
    s_cmp_ge_u32 s61, 3
    s_cselect_b32 s30, s30, s61
    s_lshl_b32 s30, s30, 15
    s_add_u32 s30, s30, s38
    s_add_u32 s31, s31, s38
    s_add_u32 m0, s30, 0
    s_add_u32 s47, s31, 0
    buffer_load_dwordx4 v3, s[12:15], s47 offen offset:0 lds
    buffer_load_dwordx4 v3, s[12:15], s47 offen offset:1024 lds
    buffer_load_dwordx4 v3, s[12:15], s47 offen offset:2048 lds
    buffer_load_dwordx4 v3, s[12:15], s47 offen offset:3072 lds
    s_add_u32 m0, s30, 4096
    s_add_u32 s47, s31, 4096
    buffer_load_dwordx4 v3, s[12:15], s47 offen offset:0 lds
    buffer_load_dwordx4 v3, s[12:15], s47 offen offset:1024 lds
    buffer_load_dwordx4 v3, s[12:15], s47 offen offset:2048 lds
    buffer_load_dwordx4 v3, s[12:15], s47 offen offset:3072 lds
G1c_k1_q_attn_kernel_31:
    s_add_u32 s39, s39, 1
    s_branch T6_k1_q_attn_kernel_28
MD_k1_q_attn_kernel_10:
    s_cmp_eq_u32 s39, 0
    s_cbranch_scc1 MID0_k1_q_attn_kernel_2
    s_cmp_eq_u32 s39, 2
    s_cbranch_scc1 MID2_k1_q_attn_kernel_4
    s_cmp_eq_u32 s39, 4
    s_cbranch_scc1 MID4_k1_q_attn_kernel_6
    s_cmp_eq_u32 s39, 5
    s_cbranch_scc1 MID5_k1_q_attn_kernel_7
    s_cmp_eq_u32 s39, 6
    s_cbranch_scc1 MID6_k1_q_attn_kernel_8
    s_cmp_eq_u32 s39, 7
    s_cbranch_scc1 MID7_k1_q_attn_kernel_9
    s_branch MR_k1_q_attn_kernel_29
MID0_k1_q_attn_kernel_2:
    s_mov_b32 s30, 0
    s_add_u32 m0, s56, 0
    s_nop 0
    buffer_load_dwordx4 v188, s[20:23], s30 offen lds
    s_add_u32 m0, s56, 1024
    s_nop 0
    buffer_load_dwordx4 v189, s[20:23], s30 offen lds
    s_add_u32 m0, s56, 2048
    s_nop 0
    buffer_load_dwordx4 v190, s[20:23], s30 offen lds
    s_add_u32 m0, s56, 3072
    s_nop 0
    buffer_load_dwordx4 v191, s[20:23], s30 offen lds
    s_add_u32 m0, s56, 4096
    s_nop 0
    buffer_load_dwordx4 v192, s[20:23], s30 offen lds
    s_add_u32 m0, s56, 5120
    s_nop 0
    buffer_load_dwordx4 v193, s[20:23], s30 offen lds
    s_add_u32 m0, s56, 6144
    s_nop 0
    buffer_load_dwordx4 v194, s[20:23], s30 offen lds
    s_branch MR_k1_q_attn_kernel_29
MID2_k1_q_attn_kernel_4:
    s_waitcnt vmcnt(0)
    ds_read_b64_tr_b16 v[104:105], v181 offset:0
    ds_read_b64_tr_b16 v[106:107], v181 offset:3584
    ds_read_b64_tr_b16 v[108:109], v181 offset:32
    ds_read_b64_tr_b16 v[110:111], v181 offset:3616
    ds_read_b64_tr_b16 v[112:113], v181 offset:64
    ds_read_b64_tr_b16 v[114:115], v181 offset:3648
    ds_read_b64_tr_b16 v[116:117], v181 offset:96
    ds_read_b64_tr_b16 v[118:119], v181 offset:3680
    ds_read_b64_tr_b16 v[120:121], v181 offset:128
    ds_read_b64_tr_b16 v[122:123], v181 offset:3712
    ds_read_b64_tr_b16 v[124:125], v181 offset:160
    ds_read_b64_tr_b16 v[126:127], v181 offset:3744
    ds_read_b64_tr_b16 v[128:129], v181 offset:192
    ds_read_b64_tr_b16 v[130:131], v181 offset:3776
    s_waitcnt lgkmcnt(0)
    v_mfma_f32_16x16x32_bf16 v[16:19], v[104:107], v[184:187], 0
    v_mfma_f32_16x16x32_bf16 v[20:23], v[108:111], v[184:187], 0
    v_mfma_f32_16x16x32_bf16 v[24:27], v[112:115], v[184:187], 0
    v_mfma_f32_16x16x32_bf16 v[28:31], v[116:119], v[184:187], 0
    v_mfma_f32_16x16x32_bf16 v[32:35], v[120:123], v[184:187], 0
    v_mfma_f32_16x16x32_bf16 v[36:39], v[124:127], v[184:187], 0
    v_mfma_f32_16x16x32_bf16 v[40:43], v[128:131], v[184:187], 0
    s_mov_b32 s30, 229376
    s_add_u32 m0, s56, 28672
    s_nop 0
    buffer_load_dwordx4 v188, s[20:23], s30 offen lds
    s_add_u32 m0, s56, 29696
    s_nop 0
    buffer_load_dwordx4 v189, s[20:23], s30 offen lds
    s_add_u32 m0, s56, 30720
    s_nop 0
    buffer_load_dwordx4 v190, s[20:23], s30 offen lds
    s_add_u32 m0, s56, 31744
    s_nop 0
    buffer_load_dwordx4 v191, s[20:23], s30 offen lds
    s_add_u32 m0, s56, 32768
    s_nop 0
    buffer_load_dwordx4 v192, s[20:23], s30 offen lds
    s_add_u32 m0, s56, 33792
    s_nop 0
    buffer_load_dwordx4 v193, s[20:23], s30 offen lds
    s_add_u32 m0, s56, 34816
    s_nop 0
    buffer_load_dwordx4 v194, s[20:23], s30 offen lds
    s_branch MR_k1_q_attn_kernel_29
MID4_k1_q_attn_kernel_6:
    s_waitcnt vmcnt(0)
    ds_read_b64_tr_b16 v[104:105], v181 offset:28672
    ds_read_b64_tr_b16 v[106:107], v181 offset:32256
    ds_read_b64_tr_b16 v[108:109], v181 offset:28704
    ds_read_b64_tr_b16 v[110:111], v181 offset:32288
    ds_read_b64_tr_b16 v[112:113], v181 offset:28736
    ds_read_b64_tr_b16 v[114:115], v181 offset:32320
    ds_read_b64_tr_b16 v[116:117], v181 offset:28768
    ds_read_b64_tr_b16 v[118:119], v181 offset:32352
    ds_read_b64_tr_b16 v[120:121], v181 offset:28800
    ds_read_b64_tr_b16 v[122:123], v181 offset:32384
    ds_read_b64_tr_b16 v[124:125], v181 offset:28832
    ds_read_b64_tr_b16 v[126:127], v181 offset:32416
    ds_read_b64_tr_b16 v[128:129], v181 offset:28864
    ds_read_b64_tr_b16 v[130:131], v181 offset:32448
    s_waitcnt lgkmcnt(0)
    v_mfma_f32_16x16x32_bf16 v[16:19], v[104:107], v[184:187], v[16:19]
    v_mfma_f32_16x16x32_bf16 v[20:23], v[108:111], v[184:187], v[20:23]
    v_mfma_f32_16x16x32_bf16 v[24:27], v[112:115], v[184:187], v[24:27]
    v_mfma_f32_16x16x32_bf16 v[28:31], v[116:119], v[184:187], v[28:31]
    v_mfma_f32_16x16x32_bf16 v[32:35], v[120:123], v[184:187], v[32:35]
    v_mfma_f32_16x16x32_bf16 v[36:39], v[124:127], v[184:187], v[36:39]
    v_mfma_f32_16x16x32_bf16 v[40:43], v[128:131], v[184:187], v[40:43]
    v_lshrrev_b32 v4, 4, v2
    v_lshlrev_b32 v4, 4, v4
    s_mul_i32 s30, s33, 448
    s_add_u32 s30, s30, 155648
    v_add_u32 v4, s30, v4
    v_and_b32 v5, 15, v2
    v_cmp_eq_u32 vcc, 0, v5
    s_and_saveexec_b64 s[66:67], vcc
    s_nop 1
    ds_write_b128 v4, v[16:19] offset:0
    ds_write_b128 v4, v[20:23] offset:64
    ds_write_b128 v4, v[24:27] offset:128
    ds_write_b128 v4, v[28:31] offset:192
    ds_write_b128 v4, v[32:35] offset:256
    ds_write_b128 v4, v[36:39] offset:320
    ds_write_b128 v4, v[40:43] offset:384
    s_mov_b64 exec, s[66:67]
    s_waitcnt lgkmcnt(0)
    s_mov_b32 s30, 0
    buffer_load_dwordx4 v[196:199], v182, s[52:55], s30 offen
    s_mov_b32 s30, 16384
    buffer_load_dwordx4 v[200:203], v182, s[52:55], s30 offen
    s_mov_b32 s30, 32768
    buffer_load_dwordx4 v[204:207], v182, s[52:55], s30 offen
    s_mov_b32 s30, 49152
    buffer_load_dwordx4 v[208:211], v182, s[52:55], s30 offen
    s_mov_b32 s30, 65536
    buffer_load_dwordx4 v[212:215], v182, s[52:55], s30 offen
    s_mov_b32 s30, 81920
    buffer_load_dwordx4 v[216:219], v182, s[52:55], s30 offen
    s_mov_b32 s30, 98304
    buffer_load_dwordx4 v[220:223], v182, s[52:55], s30 offen
    s_branch MR_k1_q_attn_kernel_29
MID5_k1_q_attn_kernel_7:
    v_cmp_gt_u32 vcc, 112, v0
    s_and_saveexec_b64 s[66:67], vcc
    s_cbranch_execz CSS_k1_q_attn_kernel_32
    v_lshlrev_b32 v4, 2, v0
    v_add_u32 v4, 155648, v4
    ds_read_b32 v16, v4 offset:0
    ds_read_b32 v17, v4 offset:448
    ds_read_b32 v18, v4 offset:896
    ds_read_b32 v19, v4 offset:1344
    s_and_b32 s30, s2, 3
    s_mul_i32 s30, s30, 28672
    s_lshr_b32 s31, s2, 7
    s_mul_i32 s31, s31, 14336
    s_add_u32 s30, s30, s31
    s_bfe_u32 s31, s2, 0x50002
    s_mul_i32 s31, s31, 448
    s_add_u32 s30, s30, s31
    v_lshlrev_b32 v4, 2, v0
    s_waitcnt lgkmcnt(0)
    v_add_f32 v16, v16, v17
    v_add_f32 v18, v18, v19
    v_add_f32 v16, v16, v18
    buffer_store_dword v16, v4, s[24:27], s30 offen
CSS_k1_q_attn_kernel_32:
    s_mov_b64 exec, s[66:67]
    s_mov_b32 m0, 157696
    s_add_u32 s47, s62, 0
    buffer_load_dwordx4 v3, s[48:51], s47 offen lds
    s_add_u32 s47, s62, 1024
    buffer_load_dwordx4 v3, s[48:51], s47 offen lds
    s_add_u32 s47, s62, 2048
    buffer_load_dwordx4 v3, s[48:51], s47 offen lds
    s_add_u32 s47, s62, 3072
    buffer_load_dwordx4 v3, s[48:51], s47 offen lds
    s_add_u32 s47, s62, 4096
    buffer_load_dwordx4 v3, s[48:51], s47 offen lds
    s_add_u32 s47, s62, 5120
    buffer_load_dwordx4 v3, s[48:51], s47 offen lds
    s_add_u32 s47, s62, 6144
    buffer_load_dwordx4 v3, s[48:51], s47 offen lds
    s_add_u32 s47, s62, 7168
    buffer_load_dwordx4 v3, s[48:51], s47 offen lds
    s_branch MR_k1_q_attn_kernel_29
MID6_k1_q_attn_kernel_8:
    s_waitcnt vmcnt(8)
    s_add_u32 s30, s63, 0
    buffer_store_dwordx4 v[196:199], v3, s[72:75], s30 offen sc1
    s_add_u32 s30, s63, 1024
    buffer_store_dwordx4 v[200:203], v3, s[72:75], s30 offen sc1
    s_add_u32 s30, s63, 2048
    buffer_store_dwordx4 v[204:207], v3, s[72:75], s30 offen sc1
    s_add_u32 s30, s63, 3072
    buffer_store_dwordx4 v[208:211], v3, s[72:75], s30 offen sc1
    s_add_u32 s30, s63, 4096
    buffer_store_dwordx4 v[212:215], v3, s[72:75], s30 offen sc1
    s_add_u32 s30, s63, 5120
    buffer_store_dwordx4 v[216:219], v3, s[72:75], s30 offen sc1
    s_add_u32 s30, s63, 6144
    buffer_store_dwordx4 v[220:223], v3, s[72:75], s30 offen sc1
    s_branch MR_k1_q_attn_kernel_29
MID7_k1_q_attn_kernel_9:
    s_mov_b32 m0, 157696
    s_add_u32 s47, s62, 8192
    buffer_load_dwordx4 v3, s[48:51], s47 offen lds
    s_add_u32 s47, s62, 9216
    buffer_load_dwordx4 v3, s[48:51], s47 offen lds
    s_add_u32 s47, s62, 10240
    buffer_load_dwordx4 v3, s[48:51], s47 offen lds
    s_add_u32 s47, s62, 11264
    buffer_load_dwordx4 v3, s[48:51], s47 offen lds
    s_add_u32 s47, s62, 12288
    buffer_load_dwordx4 v3, s[48:51], s47 offen lds
    s_add_u32 s47, s62, 13312
    buffer_load_dwordx4 v3, s[48:51], s47 offen lds
    s_add_u32 s47, s62, 14336
    buffer_load_dwordx4 v3, s[48:51], s47 offen lds
    s_add_u32 s47, s62, 15360
    buffer_load_dwordx4 v3, s[48:51], s47 offen lds
    s_getpc_b64 s[76:77]
PC_k1_q_attn_kernel_33:
    s_add_u32 s76, s76, Lcode_k2_wo_kernel-PC_k1_q_attn_kernel_33
    s_addc_u32 s77, s77, 0
    s_lshr_b32 s78, s2, 3
    s_lshl_b32 s78, s78, 10
    s_min_u32 s78, s78, 4096
    v_and_b32 v4, 63, v0
    v_lshlrev_b32 v4, 4, v4
    v_add_u32 v4, s78, v4
    global_load_dwordx4 v[132:135], v4, s[76:77]
    s_branch MR_k1_q_attn_kernel_29
X_k1_q_attn_kernel_12:
    s_waitcnt lgkmcnt(0)
    v_mfma_f32_32x32x16_bf16 v[152:167], v[92:95], v[100:103], v[152:167]
    v_mfma_f32_16x16x32_bf16 v[168:171], v[172:175], v[100:103], v[168:171]
    s_nop 11
    v_mov_b32 v8, 0
    v_fmac_f32 v8, 0, v152
    v_fmac_f32 v8, 0, v153
    v_fmac_f32 v8, 0, v154
    v_fmac_f32 v8, 0, v155
    v_fmac_f32 v8, 0, v156
    v_fmac_f32 v8, 0, v157
    v_fmac_f32 v8, 0, v158
    v_fmac_f32 v8, 0, v159
    v_fmac_f32 v8, 0, v160
    v_fmac_f32 v8, 0, v161
    v_fmac_f32 v8, 0, v162
    v_fmac_f32 v8, 0, v163
    v_fmac_f32 v8, 0, v164
    v_fmac_f32 v8, 0, v165
    v_fmac_f32 v8, 0, v166
    v_fmac_f32 v8, 0, v167
    v_mov_b32 v9, 0x21800000
    v_mov_b32 v10, 0x5d800000
    v_cmp_o_f32 s[64:65], v8, v8
    v_cmp_le_f32 s[66:67], v9, v168
    v_cmp_ge_f32 s[70:71], v10, v168
    s_and_b64 s[64:65], s[64:65], s[66:67]
    s_and_b64 s[64:65], s[64:65], s[70:71]
    s_cmp_eq_u64 s[64:65], exec
    s_cbranch_scc0 FB_k1_q_attn_kernel_34
FIN_k1_q_attn_kernel_35:
    v_rcp_f32 v8, v168
    s_nop 0
    v_mul_f32 v152, v152, v8
    v_mul_f32 v153, v153, v8
    v_mul_f32 v154, v154, v8
    v_mul_f32 v155, v155, v8
    v_mul_f32 v156, v156, v8
    v_mul_f32 v157, v157, v8
    v_mul_f32 v158, v158, v8
    v_mul_f32 v159, v159, v8
    v_mul_f32 v160, v160, v8
    v_mul_f32 v161, v161, v8
    v_mul_f32 v162, v162, v8
    v_mul_f32 v163, v163, v8
    v_mul_f32 v164, v164, v8
    v_mul_f32 v165, v165, v8
    v_mul_f32 v166, v166, v8
    v_mul_f32 v167, v167, v8
    v_cvt_pk_bf16_f32 v16, v152, v153
    v_cvt_pk_bf16_f32 v17, v154, v155
    v_cvt_pk_bf16_f32 v18, v156, v157
    v_cvt_pk_bf16_f32 v19, v158, v159
    v_cvt_pk_bf16_f32 v20, v160, v161
    v_cvt_pk_bf16_f32 v21, v162, v163
    v_cvt_pk_bf16_f32 v22, v164, v165
    v_cvt_pk_bf16_f32 v23, v166, v167
    buffer_store_dwordx4 v[16:19], v180, s[16:19], 0 offen offset:0 sc1
    buffer_store_dwordx4 v[20:23], v180, s[16:19], 0 offen offset:1024 sc1
    s_waitcnt vmcnt(0)
    s_endpgm
FB_k1_q_attn_kernel_34:
    s_waitcnt vmcnt(0)
    v_and_b32 v8, 31, v2
    v_bfe_u32 v9, v2, 2, 2
    v_lshrrev_b32 v10, 5, v2
    v_xor_b32 v9, v9, v10
    v_lshlrev_b32 v8, 6, v8
    v_lshl_add_u32 v176, v9, 4, v8
    v_xor_b32 v9, 2, v9
    v_lshl_add_u32 v177, v9, 4, v8
    v_mov_b32 v8, 0xff800000
    s_mov_b32 s47, 0
F1_k1_q_attn_kernel_36:
    buffer_load_dwordx4 v[80:83], v176, s[12:15], s47 offen
    buffer_load_dwordx4 v[84:87], v177, s[12:15], s47 offen
    s_waitcnt vmcnt(0)
    v_mfma_f32_32x32x16_bf16 v[48:63], v[80:83], v[144:147], 0
    v_mfma_f32_32x32x16_bf16 v[48:63], v[84:87], v[148:151], v[48:63]
    s_nop 11
    v_max_f32 v8, v8, v48
    v_max_f32 v8, v8, v49
    v_max_f32 v8, v8, v50
    v_max_f32 v8, v8, v51
    v_max_f32 v8, v8, v52
    v_max_f32 v8, v8, v53
    v_max_f32 v8, v8, v54
    v_max_f32 v8, v8, v55
    v_max_f32 v8, v8, v56
    v_max_f32 v8, v8, v57
    v_max_f32 v8, v8, v58
    v_max_f32 v8, v8, v59
    v_max_f32 v8, v8, v60
    v_max_f32 v8, v8, v61
    v_max_f32 v8, v8, v62
    v_max_f32 v8, v8, v63
    s_add_u32 s47, s47, 4096
    s_cmp_lt_u32 s47, 262144
    s_cbranch_scc1 F1_k1_q_attn_kernel_36
    v_mov_b32 v10, v8
    s_nop 1
    v_permlane32_swap_b32 v8, v10
    s_nop 1
    v_max_f32 v8, v8, v10
    v_mov_b32 v152, 0
    v_mov_b32 v153, 0
    v_mov_b32 v154, 0
    v_mov_b32 v155, 0
    v_mov_b32 v156, 0
    v_mov_b32 v157, 0
    v_mov_b32 v158, 0
    v_mov_b32 v159, 0
    v_mov_b32 v160, 0
    v_mov_b32 v161, 0
    v_mov_b32 v162, 0
    v_mov_b32 v163, 0
    v_mov_b32 v164, 0
    v_mov_b32 v165, 0
    v_mov_b32 v166, 0
    v_mov_b32 v167, 0
    v_mov_b32 v168, 0
    v_mov_b32 v169, 0
    v_mov_b32 v170, 0
    v_mov_b32 v171, 0
    s_mov_b32 s47, 0
F2_k1_q_attn_kernel_37:
    buffer_load_dwordx4 v[80:83], v176, s[12:15], s47 offen
    buffer_load_dwordx4 v[84:87], v177, s[12:15], s47 offen
    buffer_load_dwordx4 v[88:91], v176, s[12:15], s47 offen offset:2048
    buffer_load_dwordx4 v[92:95], v177, s[12:15], s47 offen offset:2048
    s_waitcnt vmcnt(0)
    v_mfma_f32_32x32x16_bf16 v[48:63], v[80:83], v[144:147], 0
    v_mfma_f32_32x32x16_bf16 v[48:63], v[84:87], v[148:151], v[48:63]
    s_nop 11
    v_sub_f32 v48, v48, v8
    v_sub_f32 v49, v49, v8
    v_sub_f32 v50, v50, v8
    v_sub_f32 v51, v51, v8
    v_sub_f32 v52, v52, v8
    v_sub_f32 v53, v53, v8
    v_sub_f32 v54, v54, v8
    v_sub_f32 v55, v55, v8
    v_sub_f32 v56, v56, v8
    v_sub_f32 v57, v57, v8
    v_sub_f32 v58, v58, v8
    v_sub_f32 v59, v59, v8
    v_sub_f32 v60, v60, v8
    v_sub_f32 v61, v61, v8
    v_sub_f32 v62, v62, v8
    v_sub_f32 v63, v63, v8
    v_exp_f32 v48, v48
    v_exp_f32 v49, v49
    v_exp_f32 v50, v50
    v_exp_f32 v51, v51
    v_exp_f32 v52, v52
    v_exp_f32 v53, v53
    v_exp_f32 v54, v54
    v_exp_f32 v55, v55
    v_exp_f32 v56, v56
    v_exp_f32 v57, v57
    v_exp_f32 v58, v58
    v_exp_f32 v59, v59
    v_exp_f32 v60, v60
    v_exp_f32 v61, v61
    v_exp_f32 v62, v62
    v_exp_f32 v63, v63
    s_nop 0
    v_cvt_pk_bf16_f32 v96, v48, v49
    v_cvt_pk_bf16_f32 v97, v50, v51
    v_cvt_pk_bf16_f32 v98, v52, v53
    v_cvt_pk_bf16_f32 v99, v54, v55
    v_cvt_pk_bf16_f32 v100, v56, v57
    v_cvt_pk_bf16_f32 v101, v58, v59
    v_cvt_pk_bf16_f32 v102, v60, v61
    v_cvt_pk_bf16_f32 v103, v62, v63
    s_nop 1
    v_mfma_f32_32x32x16_bf16 v[152:167], v[88:91], v[96:99], v[152:167]
    v_mfma_f32_32x32x16_bf16 v[152:167], v[92:95], v[100:103], v[152:167]
    v_mfma_f32_16x16x32_bf16 v[168:171], v[172:175], v[96:99], v[168:171]
    v_mfma_f32_16x16x32_bf16 v[168:171], v[172:175], v[100:103], v[168:171]
    s_nop 11
    s_add_u32 s47, s47, 4096
    s_cmp_lt_u32 s47, 262144
    s_cbranch_scc1 F2_k1_q_attn_kernel_37
    s_branch FIN_k1_q_attn_kernel_35
END_k1_q_attn_kernel_1:
    s_endpgm

.globl k2_wo_kernel
.p2align 8
.type k2_wo_kernel,@function
k2_wo_kernel:
Lcode_k2_wo_kernel:
    s_cmp_ge_u32 s2, 256
    s_cbranch_scc1 END_k2_wo_kernel_1
    s_load_dwordx2 s[28:29], s[0:1], 88
    s_load_dwordx2 s[8:9], s[0:1], 32
    s_load_dwordx2 s[20:21], s[0:1], 0
    v_lshrrev_b32 v1, 6, v0
    v_and_b32 v2, 63, v0
    s_and_b32 s30, s2, 7
    s_lshr_b32 s31, s2, 3
    s_and_b32 s32, s31, 1
    s_lshl_b32 s30, s30, 1
    s_add_u32 s34, s30, s32
    s_lshr_b32 s35, s31, 1
    v_readfirstlane_b32 s58, v1
    s_lshl_b32 s37, s35, 7
    s_and_b32 s33, s58, 3
    s_cmp_lt_u32 s58, 4
    s_cbranch_scc1 CONS_k2_wo_kernel_2
    v_lshrrev_b32 v60, 3, v2
    s_lshl_b32 s47, s33, 4
    v_add_u32 v60, s47, v60
    s_mov_b32 s47, 2048
    v_mul_lo_u32 v60, v60, s47
    v_add_u32 v60, s37, v60
    v_bfe_u32 v61, v2, 4, 1
    v_lshlrev_b32 v61, 2, v61
    v_and_b32 v62, 7, v2
    v_xor_b32 v61, v61, v62
    v_lshl_add_u32 v8, v61, 4, v60
    v_add_u32 v9, 16384, v8
    s_lshl_b32 s46, s33, 11
    s_mov_b32 s42, 0
    s_mov_b32 s41, 0
    s_waitcnt lgkmcnt(0)
    s_mov_b32 s10, 2097152
    s_mov_b32 s11, 0x20000
    s_add_u32 s47, s42, s46
    s_add_u32 m0, s47, 0
    s_nop 0
    buffer_load_dwordx4 v8, s[8:11], s41 offen lds
    s_add_u32 m0, s47, 1024
    s_nop 0
    buffer_load_dwordx4 v9, s[8:11], s41 offen lds
    s_add_u32 s41, s41, 131072
    s_add_u32 s42, s42, 8192
    s_cmp_eq_u32 s42, 81920
    s_cselect_b32 s42, 0, s42
    s_add_u32 s47, s42, s46
    s_add_u32 m0, s47, 0
    s_nop 0
    buffer_load_dwordx4 v8, s[8:11], s41 offen lds
    s_add_u32 m0, s47, 1024
    s_nop 0
    buffer_load_dwordx4 v9, s[8:11], s41 offen lds
    s_add_u32 s41, s41, 131072
    s_add_u32 s42, s42, 8192
    s_cmp_eq_u32 s42, 81920
    s_cselect_b32 s42, 0, s42
    s_add_u32 s47, s42, s46
    s_add_u32 m0, s47, 0
    s_nop 0
    buffer_load_dwordx4 v8, s[8:11], s41 offen lds
    s_add_u32 m0, s47, 1024
    s_nop 0
    buffer_load_dwordx4 v9, s[8:11], s41 offen lds
    s_add_u32 s41, s41, 131072
    s_add_u32 s42, s42, 8192
    s_cmp_eq_u32 s42, 81920
    s_cselect_b32 s42, 0, s42
    s_add_u32 s47, s42, s46
    s_add_u32 m0, s47, 0
    s_nop 0
    buffer_load_dwordx4 v8, s[8:11], s41 offen lds
    s_add_u32 m0, s47, 1024
    s_nop 0
    buffer_load_dwordx4 v9, s[8:11], s41 offen lds
    s_add_u32 s41, s41, 131072
    s_add_u32 s42, s42, 8192
    s_cmp_eq_u32 s42, 81920
    s_cselect_b32 s42, 0, s42
    s_add_u32 s47, s42, s46
    s_add_u32 m0, s47, 0
    s_nop 0
    buffer_load_dwordx4 v8, s[8:11], s41 offen lds
    s_add_u32 m0, s47, 1024
    s_nop 0
    buffer_load_dwordx4 v9, s[8:11], s41 offen lds
    s_add_u32 s41, s41, 131072
    s_add_u32 s42, s42, 8192
    s_cmp_eq_u32 s42, 81920
    s_cselect_b32 s42, 0, s42
    s_add_u32 s47, s42, s46
    s_add_u32 m0, s47, 0
    s_nop 0
    buffer_load_dwordx4 v8, s[8:11], s41 offen lds
    s_add_u32 m0, s47, 1024
    s_nop 0
    buffer_load_dwordx4 v9, s[8:11], s41 offen lds
    s_add_u32 s41, s41, 131072
    s_add_u32 s42, s42, 8192
    s_cmp_eq_u32 s42, 81920
    s_cselect_b32 s42, 0, s42
    s_add_u32 s47, s42, s46
    s_add_u32 m0, s47, 0
    s_nop 0
    buffer_load_dwordx4 v8, s[8:11], s41 offen lds
    s_add_u32 m0, s47, 1024
    s_nop 0
    buffer_load_dwordx4 v9, s[8:11], s41 offen lds
    s_add_u32 s41, s41, 131072
    s_add_u32 s42, s42, 8192
    s_cmp_eq_u32 s42, 81920
    s_cselect_b32 s42, 0, s42
    s_add_u32 s47, s42, s46
    s_add_u32 m0, s47, 0
    s_nop 0
    buffer_load_dwordx4 v8, s[8:11], s41 offen lds
    s_add_u32 m0, s47, 1024
    s_nop 0
    buffer_load_dwordx4 v9, s[8:11], s41 offen lds
    s_add_u32 s41, s41, 131072
    s_add_u32 s42, s42, 8192
    s_cmp_eq_u32 s42, 81920
    s_cselect_b32 s42, 0, s42
    s_add_u32 s47, s42, s46
    s_add_u32 m0, s47, 0
    s_nop 0
    buffer_load_dwordx4 v8, s[8:11], s41 offen lds
    s_add_u32 m0, s47, 1024
    s_nop 0
    buffer_load_dwordx4 v9, s[8:11], s41 offen lds
    s_add_u32 s41, s41, 131072
    s_add_u32 s42, s42, 8192
    s_cmp_eq_u32 s42, 81920
    s_cselect_b32 s42, 0, s42
    s_waitcnt vmcnt(16)
    s_barrier
    s_mov_b32 s39, 7
LD_k2_wo_kernel_3:
    s_waitcnt vmcnt(14)
    s_barrier
    s_add_u32 s47, s42, s46
    s_add_u32 m0, s47, 0
    s_nop 0
    buffer_load_dwordx4 v8, s[8:11], s41 offen lds
    s_add_u32 m0, s47, 1024
    s_nop 0
    buffer_load_dwordx4 v9, s[8:11], s41 offen lds
    s_add_u32 s41, s41, 131072
    s_add_u32 s42, s42, 8192
    s_cmp_eq_u32 s42, 81920
    s_cselect_b32 s42, 0, s42
    s_sub_u32 s39, s39, 1
    s_cmp_lg_u32 s39, 0
    s_cbranch_scc1 LD_k2_wo_kernel_3
    s_waitcnt vmcnt(14)
    s_barrier
    s_waitcnt vmcnt(12)
    s_barrier
    s_waitcnt vmcnt(10)
    s_barrier
    s_waitcnt vmcnt(8)
    s_barrier
    s_waitcnt vmcnt(6)
    s_barrier
    s_waitcnt vmcnt(4)
    s_barrier
    s_waitcnt vmcnt(2)
    s_barrier
    s_waitcnt vmcnt(0)
    s_barrier
    s_getpc_b64 s[56:57]
PC_k2_wo_kernel_4:
    s_add_u32 s56, s56, Lcode_k3_gateup_kernel-PC_k2_wo_kernel_4
    s_addc_u32 s57, s57, 0
    s_lshr_b32 s58, s2, 3
    s_lshl_b32 s58, s58, 10
    s_min_u32 s58, s58, 11264
    v_and_b32 v4, 63, v0
    v_lshlrev_b32 v4, 4, v4
    v_add_u32 v4, s58, v4
    global_load_dwordx4 v[12:15], v4, s[56:57]
    s_endpgm
CONS_k2_wo_kernel_2:
    s_lshr_b32 s30, s34, 1
    s_lshl_b32 s30, s30, 5
    s_lshl_b32 s31, s35, 1
    s_add_u32 s30, s30, s31
    s_lshl_b32 s30, s30, 14
    s_and_b32 s31, s34, 1
    s_lshl_b32 s31, s31, 13
    s_add_u32 s30, s30, s31
    s_lshl_b32 s31, s33, 11
    s_add_u32 s30, s30, s31
    v_bfe_u32 v60, v2, 4, 1
    v_lshlrev_b32 v60, 10, v60
    v_and_b32 v61, 15, v2
    v_lshl_add_u32 v60, v61, 4, v60
    v_lshrrev_b32 v61, 5, v2
    v_lshl_add_u32 v60, v61, 3, v60
    v_add_u32 v88, s30, v60
    v_add_u32 v89, 256, v88
    v_add_u32 v90, 512, v88
    v_add_u32 v91, 768, v88
    s_lshl_b32 s30, s34, 7
    s_lshl_b32 s31, s33, 5
    s_add_u32 s30, s30, s31
    v_and_b32 v60, 31, v2
    v_add_u32 v61, s30, v60
    v_lshlrev_b32 v60, 11, v61
    v_lshrrev_b32 v62, 5, v2
    v_lshl_add_u32 v60, v62, 5, v60
    v_add_u32 v92, s37, v60
    s_mov_b32 s48, 16384
    v_lshlrev_b32 v61, 3, v61
    s_lshl_b32 s30, s35, 14
    v_add_u32 v93, s30, v61
    s_lshl_b32 s36, s34, 2
    s_add_u32 s36, s36, s33
    s_mul_i32 s36, s36, 65536
    v_lshlrev_b32 v4, 4, v2
    v_add_u32 v4, s36, v4
    v_lshrrev_b32 v60, 5, v2
    v_lshlrev_b32 v60, 4, v60
    v_bfe_u32 v61, v2, 2, 2
    v_add_u32 v60, v60, v61
    v_lshlrev_b32 v60, 7, v60
    v_and_b32 v61, 1, v2
    v_lshlrev_b32 v61, 1, v61
    v_bfe_u32 v62, v2, 4, 1
    v_add_u32 v61, v61, v62
    v_bfe_u32 v62, v2, 3, 1
    v_lshlrev_b32 v62, 2, v62
    v_xor_b32 v61, v61, v62
    v_bfe_u32 v62, v2, 1, 1
    v_lshlrev_b32 v62, 3, v62
    v_add_u32 v60, v60, v62
    v_lshl_add_u32 v14, v61, 4, v60
    v_xor_b32 v61, 4, v61
    v_lshl_add_u32 v15, v61, 4, v60
    s_mov_b32 s43, 0
    s_mov_b32 s40, 0
    v_mov_b32 v40, 0
    v_mov_b32 v41, 0
    v_mov_b32 v42, 0
    v_mov_b32 v43, 0
    v_mov_b32 v44, 0
    v_mov_b32 v45, 0
    v_mov_b32 v46, 0
    v_mov_b32 v47, 0
    v_mov_b32 v48, 0
    v_mov_b32 v49, 0
    v_mov_b32 v50, 0
    v_mov_b32 v51, 0
    v_mov_b32 v52, 0
    v_mov_b32 v53, 0
    v_mov_b32 v54, 0
    v_mov_b32 v55, 0
    v_mov_b32 v56, 0
    v_mov_b32 v57, 0
    v_mov_b32 v58, 0
    v_mov_b32 v59, 0
    v_mov_b32 v60, 0
    v_mov_b32 v61, 0
    v_mov_b32 v62, 0
    v_mov_b32 v63, 0
    v_mov_b32 v64, 0
    v_mov_b32 v65, 0
    v_mov_b32 v66, 0
    v_mov_b32 v67, 0
    v_mov_b32 v68, 0
    v_mov_b32 v69, 0
    v_mov_b32 v70, 0
    v_mov_b32 v71, 0
    s_waitcnt lgkmcnt(0)
    s_add_u32 s4, s28, 5242880
    s_addc_u32 s5, s29, 0
    s_mov_b32 s6, 4194304
    s_mov_b32 s7, 0x20000
    s_add_u32 s12, s28, 9437184
    s_addc_u32 s13, s29, 0
    s_mov_b32 s14, 4194304
    s_mov_b32 s15, 0x20000
    s_mov_b32 s22, 4194304
    s_mov_b32 s23, 0x20000
    s_add_u32 s16, s28, 13631488
    s_addc_u32 s17, s29, 0
    s_mov_b32 s18, 262144
    s_mov_b32 s19, 0x20000
    buffer_load_dwordx4 v[128:131], v4, s[4:7], s40 offen offset:0
    buffer_load_dwordx4 v[132:135], v4, s[4:7], s40 offen offset:1024
    buffer_load_dwordx4 v[136:139], v4, s[4:7], s40 offen offset:2048
    buffer_load_dwordx4 v[140:143], v4, s[4:7], s40 offen offset:3072
    s_add_u32 s40, s40, 4096
    buffer_load_dwordx4 v[144:147], v4, s[4:7], s40 offen offset:0
    buffer_load_dwordx4 v[148:151], v4, s[4:7], s40 offen offset:1024
    buffer_load_dwordx4 v[152:155], v4, s[4:7], s40 offen offset:2048
    buffer_load_dwordx4 v[156:159], v4, s[4:7], s40 offen offset:3072
    s_add_u32 s40, s40, 4096
    buffer_load_dwordx4 v[160:163], v4, s[4:7], s40 offen offset:0
    buffer_load_dwordx4 v[164:167], v4, s[4:7], s40 offen offset:1024
    buffer_load_dwordx4 v[168:171], v4, s[4:7], s40 offen offset:2048
    buffer_load_dwordx4 v[172:175], v4, s[4:7], s40 offen offset:3072
    s_add_u32 s40, s40, 4096
    buffer_load_dwordx4 v[176:179], v4, s[4:7], s40 offen offset:0
    buffer_load_dwordx4 v[180:183], v4, s[4:7], s40 offen offset:1024
    buffer_load_dwordx4 v[184:187], v4, s[4:7], s40 offen offset:2048
    buffer_load_dwordx4 v[188:191], v4, s[4:7], s40 offen offset:3072
    s_add_u32 s40, s40, 4096
    s_setprio 1
    s_barrier
    ds_read_b64_tr_b16 v[96:97], v14 offset:0
    ds_read_b64_tr_b16 v[98:99], v14 offset:512
    ds_read_b64_tr_b16 v[100:101], v15 offset:0
    ds_read_b64_tr_b16 v[102:103], v15 offset:512
    ds_read_b64_tr_b16 v[104:105], v14 offset:1024
    ds_read_b64_tr_b16 v[106:107], v14 offset:1536
    ds_read_b64_tr_b16 v[108:109], v15 offset:1024
    ds_read_b64_tr_b16 v[110:111], v15 offset:1536
    s_mov_b32 s39, 3
CS_k2_wo_kernel_5:
    s_waitcnt vmcnt(15) lgkmcnt(4)
    v_mfma_f32_32x32x16_bf16 v[40:55], v[96:99], v[128:131], v[40:55]
    ds_read_b64_tr_b16 v[112:113], v14 offset:4096
    ds_read_b64_tr_b16 v[114:115], v14 offset:4608
    v_mfma_f32_32x32x16_bf16 v[56:71], v[100:103], v[128:131], v[56:71]
    ds_read_b64_tr_b16 v[116:117], v15 offset:4096
    ds_read_b64_tr_b16 v[118:119], v15 offset:4608
    buffer_load_dwordx4 v[128:131], v4, s[4:7], s40 offen offset:0
    s_waitcnt vmcnt(15) lgkmcnt(4)
    v_mfma_f32_32x32x16_bf16 v[40:55], v[104:107], v[132:135], v[40:55]
    ds_read_b64_tr_b16 v[120:121], v14 offset:5120
    ds_read_b64_tr_b16 v[122:123], v14 offset:5632
    s_add_u32 s47, s43, 8192
    s_cmp_eq_u32 s47, 81920
    s_cselect_b32 s47, 0, s47
    s_sub_u32 s44, s47, s43
    s_mov_b32 s43, s47
    v_mfma_f32_32x32x16_bf16 v[56:71], v[108:111], v[132:135], v[56:71]
    ds_read_b64_tr_b16 v[124:125], v15 offset:5120
    ds_read_b64_tr_b16 v[126:127], v15 offset:5632
    buffer_load_dwordx4 v[132:135], v4, s[4:7], s40 offen offset:1024
    s_barrier
    v_add_u32 v14, s44, v14
    v_add_u32 v15, s44, v15
    s_waitcnt vmcnt(15) lgkmcnt(4)
    v_mfma_f32_32x32x16_bf16 v[40:55], v[112:115], v[136:139], v[40:55]
    ds_read_b64_tr_b16 v[96:97], v14 offset:0
    ds_read_b64_tr_b16 v[98:99], v14 offset:512
    v_mfma_f32_32x32x16_bf16 v[56:71], v[116:119], v[136:139], v[56:71]
    ds_read_b64_tr_b16 v[100:101], v15 offset:0
    ds_read_b64_tr_b16 v[102:103], v15 offset:512
    buffer_load_dwordx4 v[136:139], v4, s[4:7], s40 offen offset:2048
    s_waitcnt vmcnt(15) lgkmcnt(4)
    v_mfma_f32_32x32x16_bf16 v[40:55], v[120:123], v[140:143], v[40:55]
    ds_read_b64_tr_b16 v[104:105], v14 offset:1024
    ds_read_b64_tr_b16 v[106:107], v14 offset:1536
    v_mfma_f32_32x32x16_bf16 v[56:71], v[124:127], v[140:143], v[56:71]
    ds_read_b64_tr_b16 v[108:109], v15 offset:1024
    ds_read_b64_tr_b16 v[110:111], v15 offset:1536
    buffer_load_dwordx4 v[140:143], v4, s[4:7], s40 offen offset:3072
    s_add_u32 s40, s40, 4096
    s_waitcnt vmcnt(15) lgkmcnt(4)
    v_mfma_f32_32x32x16_bf16 v[40:55], v[96:99], v[144:147], v[40:55]
    ds_read_b64_tr_b16 v[112:113], v14 offset:4096
    ds_read_b64_tr_b16 v[114:115], v14 offset:4608
    v_mfma_f32_32x32x16_bf16 v[56:71], v[100:103], v[144:147], v[56:71]
    ds_read_b64_tr_b16 v[116:117], v15 offset:4096
    ds_read_b64_tr_b16 v[118:119], v15 offset:4608
    buffer_load_dwordx4 v[144:147], v4, s[4:7], s40 offen offset:0
    s_waitcnt vmcnt(15) lgkmcnt(4)
    v_mfma_f32_32x32x16_bf16 v[40:55], v[104:107], v[148:151], v[40:55]
    ds_read_b64_tr_b16 v[120:121], v14 offset:5120
    ds_read_b64_tr_b16 v[122:123], v14 offset:5632
    s_add_u32 s47, s43, 8192
    s_cmp_eq_u32 s47, 81920
    s_cselect_b32 s47, 0, s47
    s_sub_u32 s44, s47, s43
    s_mov_b32 s43, s47
    v_mfma_f32_32x32x16_bf16 v[56:71], v[108:111], v[148:151], v[56:71]
    ds_read_b64_tr_b16 v[124:125], v15 offset:5120
    ds_read_b64_tr_b16 v[126:127], v15 offset:5632
    buffer_load_dwordx4 v[148:151], v4, s[4:7], s40 offen offset:1024
    s_barrier
    v_add_u32 v14, s44, v14
    v_add_u32 v15, s44, v15
    s_waitcnt vmcnt(15) lgkmcnt(4)
    v_mfma_f32_32x32x16_bf16 v[40:55], v[112:115], v[152:155], v[40:55]
    ds_read_b64_tr_b16 v[96:97], v14 offset:0
    ds_read_b64_tr_b16 v[98:99], v14 offset:512
    v_mfma_f32_32x32x16_bf16 v[56:71], v[116:119], v[152:155], v[56:71]
    ds_read_b64_tr_b16 v[100:101], v15 offset:0
    ds_read_b64_tr_b16 v[102:103], v15 offset:512
    buffer_load_dwordx4 v[152:155], v4, s[4:7], s40 offen offset:2048
    s_waitcnt vmcnt(15) lgkmcnt(4)
    v_mfma_f32_32x32x16_bf16 v[40:55], v[120:123], v[156:159], v[40:55]
    ds_read_b64_tr_b16 v[104:105], v14 offset:1024
    ds_read_b64_tr_b16 v[106:107], v14 offset:1536
    v_mfma_f32_32x32x16_bf16 v[56:71], v[124:127], v[156:159], v[56:71]
    ds_read_b64_tr_b16 v[108:109], v15 offset:1024
    ds_read_b64_tr_b16 v[110:111], v15 offset:1536
    buffer_load_dwordx4 v[156:159], v4, s[4:7], s40 offen offset:3072
    s_add_u32 s40, s40, 4096
    s_waitcnt vmcnt(15) lgkmcnt(4)
    v_mfma_f32_32x32x16_bf16 v[40:55], v[96:99], v[160:163], v[40:55]
    ds_read_b64_tr_b16 v[112:113], v14 offset:4096
    ds_read_b64_tr_b16 v[114:115], v14 offset:4608
    v_mfma_f32_32x32x16_bf16 v[56:71], v[100:103], v[160:163], v[56:71]
    ds_read_b64_tr_b16 v[116:117], v15 offset:4096
    ds_read_b64_tr_b16 v[118:119], v15 offset:4608
    buffer_load_dwordx4 v[160:163], v4, s[4:7], s40 offen offset:0
    s_waitcnt vmcnt(15) lgkmcnt(4)
    v_mfma_f32_32x32x16_bf16 v[40:55], v[104:107], v[164:167], v[40:55]
    ds_read_b64_tr_b16 v[120:121], v14 offset:5120
    ds_read_b64_tr_b16 v[122:123], v14 offset:5632
    s_add_u32 s47, s43, 8192
    s_cmp_eq_u32 s47, 81920
    s_cselect_b32 s47, 0, s47
    s_sub_u32 s44, s47, s43
    s_mov_b32 s43, s47
    v_mfma_f32_32x32x16_bf16 v[56:71], v[108:111], v[164:167], v[56:71]
    ds_read_b64_tr_b16 v[124:125], v15 offset:5120
    ds_read_b64_tr_b16 v[126:127], v15 offset:5632
    buffer_load_dwordx4 v[164:167], v4, s[4:7], s40 offen offset:1024
    s_barrier
    v_add_u32 v14, s44, v14
    v_add_u32 v15, s44, v15
    s_waitcnt vmcnt(15) lgkmcnt(4)
    v_mfma_f32_32x32x16_bf16 v[40:55], v[112:115], v[168:171], v[40:55]
    ds_read_b64_tr_b16 v[96:97], v14 offset:0
    ds_read_b64_tr_b16 v[98:99], v14 offset:512
    v_mfma_f32_32x32x16_bf16 v[56:71], v[116:119], v[168:171], v[56:71]
    ds_read_b64_tr_b16 v[100:101], v15 offset:0
    ds_read_b64_tr_b16 v[102:103], v15 offset:512
    buffer_load_dwordx4 v[168:171], v4, s[4:7], s40 offen offset:2048
    s_waitcnt vmcnt(15) lgkmcnt(4)
    v_mfma_f32_32x32x16_bf16 v[40:55], v[120:123], v[172:175], v[40:55]
    ds_read_b64_tr_b16 v[104:105], v14 offset:1024
    ds_read_b64_tr_b16 v[106:107], v14 offset:1536
    v_mfma_f32_32x32x16_bf16 v[56:71], v[124:127], v[172:175], v[56:71]
    ds_read_b64_tr_b16 v[108:109], v15 offset:1024
    ds_read_b64_tr_b16 v[110:111], v15 offset:1536
    buffer_load_dwordx4 v[172:175], v4, s[4:7], s40 offen offset:3072
    s_add_u32 s40, s40, 4096
    s_waitcnt vmcnt(15) lgkmcnt(4)
    v_mfma_f32_32x32x16_bf16 v[40:55], v[96:99], v[176:179], v[40:55]
    ds_read_b64_tr_b16 v[112:113], v14 offset:4096
    ds_read_b64_tr_b16 v[114:115], v14 offset:4608
    v_mfma_f32_32x32x16_bf16 v[56:71], v[100:103], v[176:179], v[56:71]
    ds_read_b64_tr_b16 v[116:117], v15 offset:4096
    ds_read_b64_tr_b16 v[118:119], v15 offset:4608
    buffer_load_dwordx4 v[176:179], v4, s[4:7], s40 offen offset:0
    s_waitcnt vmcnt(15) lgkmcnt(4)
    v_mfma_f32_32x32x16_bf16 v[40:55], v[104:107], v[180:183], v[40:55]
    ds_read_b64_tr_b16 v[120:121], v14 offset:5120
    ds_read_b64_tr_b16 v[122:123], v14 offset:5632
    s_add_u32 s47, s43, 8192
    s_cmp_eq_u32 s47, 81920
    s_cselect_b32 s47, 0, s47
    s_sub_u32 s44, s47, s43
    s_mov_b32 s43, s47
    v_mfma_f32_32x32x16_bf16 v[56:71], v[108:111], v[180:183], v[56:71]
    ds_read_b64_tr_b16 v[124:125], v15 offset:5120
    ds_read_b64_tr_b16 v[126:127], v15 offset:5632
    buffer_load_dwordx4 v[180:183], v4, s[4:7], s40 offen offset:1024
    s_barrier
    v_add_u32 v14, s44, v14
    v_add_u32 v15, s44, v15
    s_waitcnt vmcnt(15) lgkmcnt(4)
    v_mfma_f32_32x32x16_bf16 v[40:55], v[112:115], v[184:187], v[40:55]
    ds_read_b64_tr_b16 v[96:97], v14 offset:0
    ds_read_b64_tr_b16 v[98:99], v14 offset:512
    v_mfma_f32_32x32x16_bf16 v[56:71], v[116:119], v[184:187], v[56:71]
    ds_read_b64_tr_b16 v[100:101], v15 offset:0
    ds_read_b64_tr_b16 v[102:103], v15 offset:512
    buffer_load_dwordx4 v[184:187], v4, s[4:7], s40 offen offset:2048
    s_waitcnt vmcnt(15) lgkmcnt(4)
    v_mfma_f32_32x32x16_bf16 v[40:55], v[120:123], v[188:191], v[40:55]
    ds_read_b64_tr_b16 v[104:105], v14 offset:1024
    ds_read_b64_tr_b16 v[106:107], v14 offset:1536
    v_mfma_f32_32x32x16_bf16 v[56:71], v[124:127], v[188:191], v[56:71]
    ds_read_b64_tr_b16 v[108:109], v15 offset:1024
    ds_read_b64_tr_b16 v[110:111], v15 offset:1536
    buffer_load_dwordx4 v[188:191], v4, s[4:7], s40 offen offset:3072
    s_add_u32 s40, s40, 4096
    s_sub_u32 s39, s39, 1
    s_cmp_lg_u32 s39, 0
    s_cbranch_scc1 CS_k2_wo_kernel_5
    buffer_load_dwordx4 v[72:75], v92, s[20:23], 0 offen offset:0
    buffer_load_dwordx4 v[76:79], v92, s[20:23], 0 offen offset:16
    buffer_load_dwordx4 v[80:83], v92, s[20:23], 0 offen offset:64
    buffer_load_dwordx4 v[84:87], v92, s[20:23], 0 offen offset:80
    s_waitcnt vmcnt(19) lgkmcnt(4)
    v_mfma_f32_32x32x16_bf16 v[40:55], v[96:99], v[128:131], v[40:55]
    ds_read_b64_tr_b16 v[112:113], v14 offset:4096
    ds_read_b64_tr_b16 v[114:115], v14 offset:4608
    v_mfma_f32_32x32x16_bf16 v[56:71], v[100:103], v[128:131], v[56:71]
    ds_read_b64_tr_b16 v[116:117], v15 offset:4096
    ds_read_b64_tr_b16 v[118:119], v15 offset:4608
    s_waitcnt vmcnt(18) lgkmcnt(4)
    v_mfma_f32_32x32x16_bf16 v[40:55], v[104:107], v[132:135], v[40:55]
    ds_read_b64_tr_b16 v[120:121], v14 offset:5120
    ds_read_b64_tr_b16 v[122:123], v14 offset:5632
    s_add_u32 s47, s43, 8192
    s_cmp_eq_u32 s47, 81920
    s_cselect_b32 s47, 0, s47
    s_sub_u32 s44, s47, s43
    s_mov_b32 s43, s47
    v_mfma_f32_32x32x16_bf16 v[56:71], v[108:111], v[132:135], v[56:71]
    ds_read_b64_tr_b16 v[124:125], v15 offset:5120
    ds_read_b64_tr_b16 v[126:127], v15 offset:5632
    s_barrier
    v_add_u32 v14, s44, v14
    v_add_u32 v15, s44, v15
    s_waitcnt vmcnt(17) lgkmcnt(4)
    v_mfma_f32_32x32x16_bf16 v[40:55], v[112:115], v[136:139], v[40:55]
    ds_read_b64_tr_b16 v[96:97], v14 offset:0
    ds_read_b64_tr_b16 v[98:99], v14 offset:512
    v_mfma_f32_32x32x16_bf16 v[56:71], v[116:119], v[136:139], v[56:71]
    ds_read_b64_tr_b16 v[100:101], v15 offset:0
    ds_read_b64_tr_b16 v[102:103], v15 offset:512
    s_waitcnt vmcnt(16) lgkmcnt(4)
    v_mfma_f32_32x32x16_bf16 v[40:55], v[120:123], v[140:143], v[40:55]
    ds_read_b64_tr_b16 v[104:105], v14 offset:1024
    ds_read_b64_tr_b16 v[106:107], v14 offset:1536
    v_mfma_f32_32x32x16_bf16 v[56:71], v[124:127], v[140:143], v[56:71]
    ds_read_b64_tr_b16 v[108:109], v15 offset:1024
    ds_read_b64_tr_b16 v[110:111], v15 offset:1536
    s_waitcnt vmcnt(15) lgkmcnt(4)
    v_mfma_f32_32x32x16_bf16 v[40:55], v[96:99], v[144:147], v[40:55]
    ds_read_b64_tr_b16 v[112:113], v14 offset:4096
    ds_read_b64_tr_b16 v[114:115], v14 offset:4608
    v_mfma_f32_32x32x16_bf16 v[56:71], v[100:103], v[144:147], v[56:71]
    ds_read_b64_tr_b16 v[116:117], v15 offset:4096
    ds_read_b64_tr_b16 v[118:119], v15 offset:4608
    s_waitcnt vmcnt(14) lgkmcnt(4)
    v_mfma_f32_32x32x16_bf16 v[40:55], v[104:107], v[148:151], v[40:55]
    ds_read_b64_tr_b16 v[120:121], v14 offset:5120
    ds_read_b64_tr_b16 v[122:123], v14 offset:5632
    s_add_u32 s47, s43, 8192
    s_cmp_eq_u32 s47, 81920
    s_cselect_b32 s47, 0, s47
    s_sub_u32 s44, s47, s43
    s_mov_b32 s43, s47
    v_mfma_f32_32x32x16_bf16 v[56:71], v[108:111], v[148:151], v[56:71]
    ds_read_b64_tr_b16 v[124:125], v15 offset:5120
    ds_read_b64_tr_b16 v[126:127], v15 offset:5632
    s_barrier
    v_add_u32 v14, s44, v14
    v_add_u32 v15, s44, v15
    s_waitcnt vmcnt(13) lgkmcnt(4)
    v_mfma_f32_32x32x16_bf16 v[40:55], v[112:115], v[152:155], v[40:55]
    ds_read_b64_tr_b16 v[96:97], v14 offset:0
    ds_read_b64_tr_b16 v[98:99], v14 offset:512
    v_mfma_f32_32x32x16_bf16 v[56:71], v[116:119], v[152:155], v[56:71]
    ds_read_b64_tr_b16 v[100:101], v15 offset:0
    ds_read_b64_tr_b16 v[102:103], v15 offset:512
    s_waitcnt vmcnt(12) lgkmcnt(4)
    v_mfma_f32_32x32x16_bf16 v[40:55], v[120:123], v[156:159], v[40:55]
    ds_read_b64_tr_b16 v[104:105], v14 offset:1024
    ds_read_b64_tr_b16 v[106:107], v14 offset:1536
    v_mfma_f32_32x32x16_bf16 v[56:71], v[124:127], v[156:159], v[56:71]
    ds_read_b64_tr_b16 v[108:109], v15 offset:1024
    ds_read_b64_tr_b16 v[110:111], v15 offset:1536
    s_waitcnt vmcnt(11) lgkmcnt(4)
    v_mfma_f32_32x32x16_bf16 v[40:55], v[96:99], v[160:163], v[40:55]
    ds_read_b64_tr_b16 v[112:113], v14 offset:4096
    ds_read_b64_tr_b16 v[114:115], v14 offset:4608
    v_mfma_f32_32x32x16_bf16 v[56:71], v[100:103], v[160:163], v[56:71]
    ds_read_b64_tr_b16 v[116:117], v15 offset:4096
    ds_read_b64_tr_b16 v[118:119], v15 offset:4608
    s_waitcnt vmcnt(10) lgkmcnt(4)
    v_mfma_f32_32x32x16_bf16 v[40:55], v[104:107], v[164:167], v[40:55]
    ds_read_b64_tr_b16 v[120:121], v14 offset:5120
    ds_read_b64_tr_b16 v[122:123], v14 offset:5632
    s_add_u32 s47, s43, 8192
    s_cmp_eq_u32 s47, 81920
    s_cselect_b32 s47, 0, s47
    s_sub_u32 s44, s47, s43
    s_mov_b32 s43, s47
    v_mfma_f32_32x32x16_bf16 v[56:71], v[108:111], v[164:167], v[56:71]
    ds_read_b64_tr_b16 v[124:125], v15 offset:5120
    ds_read_b64_tr_b16 v[126:127], v15 offset:5632
    s_barrier
    v_add_u32 v14, s44, v14
    v_add_u32 v15, s44, v15
    s_waitcnt vmcnt(9) lgkmcnt(4)
    v_mfma_f32_32x32x16_bf16 v[40:55], v[112:115], v[168:171], v[40:55]
    ds_read_b64_tr_b16 v[96:97], v14 offset:0
    ds_read_b64_tr_b16 v[98:99], v14 offset:512
    v_mfma_f32_32x32x16_bf16 v[56:71], v[116:119], v[168:171], v[56:71]
    ds_read_b64_tr_b16 v[100:101], v15 offset:0
    ds_read_b64_tr_b16 v[102:103], v15 offset:512
    s_waitcnt vmcnt(8) lgkmcnt(4)
    v_mfma_f32_32x32x16_bf16 v[40:55], v[120:123], v[172:175], v[40:55]
    ds_read_b64_tr_b16 v[104:105], v14 offset:1024
    ds_read_b64_tr_b16 v[106:107], v14 offset:1536
    v_mfma_f32_32x32x16_bf16 v[56:71], v[124:127], v[172:175], v[56:71]
    ds_read_b64_tr_b16 v[108:109], v15 offset:1024
    ds_read_b64_tr_b16 v[110:111], v15 offset:1536
    s_waitcnt vmcnt(7) lgkmcnt(4)
    v_mfma_f32_32x32x16_bf16 v[40:55], v[96:99], v[176:179], v[40:55]
    ds_read_b64_tr_b16 v[112:113], v14 offset:4096
    ds_read_b64_tr_b16 v[114:115], v14 offset:4608
    v_mfma_f32_32x32x16_bf16 v[56:71], v[100:103], v[176:179], v[56:71]
    ds_read_b64_tr_b16 v[116:117], v15 offset:4096
    ds_read_b64_tr_b16 v[118:119], v15 offset:4608
    s_waitcnt vmcnt(6) lgkmcnt(4)
    v_mfma_f32_32x32x16_bf16 v[40:55], v[104:107], v[180:183], v[40:55]
    ds_read_b64_tr_b16 v[120:121], v14 offset:5120
    ds_read_b64_tr_b16 v[122:123], v14 offset:5632
    v_mfma_f32_32x32x16_bf16 v[56:71], v[108:111], v[180:183], v[56:71]
    ds_read_b64_tr_b16 v[124:125], v15 offset:5120
    ds_read_b64_tr_b16 v[126:127], v15 offset:5632
    s_waitcnt vmcnt(5) lgkmcnt(4)
    v_mfma_f32_32x32x16_bf16 v[40:55], v[112:115], v[184:187], v[40:55]
    v_mfma_f32_32x32x16_bf16 v[56:71], v[116:119], v[184:187], v[56:71]
    s_waitcnt vmcnt(4) lgkmcnt(0)
    v_mfma_f32_32x32x16_bf16 v[40:55], v[120:123], v[188:191], v[40:55]
    v_mfma_f32_32x32x16_bf16 v[56:71], v[124:127], v[188:191], v[56:71]
    s_setprio 0
    s_waitcnt vmcnt(0)
    v_lshlrev_b32 v16, 16, v72
    v_and_b32 v17, 0xffff0000, v72
    v_lshlrev_b32 v18, 16, v73
    v_and_b32 v19, 0xffff0000, v73
    v_lshlrev_b32 v20, 16, v74
    v_and_b32 v21, 0xffff0000, v74
    v_lshlrev_b32 v22, 16, v75
    v_and_b32 v23, 0xffff0000, v75
    v_lshlrev_b32 v24, 16, v76
    v_and_b32 v25, 0xffff0000, v76
    v_lshlrev_b32 v26, 16, v77
    v_and_b32 v27, 0xffff0000, v77
    v_lshlrev_b32 v28, 16, v78
    v_and_b32 v29, 0xffff0000, v78
    v_lshlrev_b32 v30, 16, v79
    v_and_b32 v31, 0xffff0000, v79
    s_nop 1
    v_pk_add_f32 v[40:41], v[40:41], v[16:17]
    v_pk_add_f32 v[42:43], v[42:43], v[18:19]
    v_pk_add_f32 v[44:45], v[44:45], v[20:21]
    v_pk_add_f32 v[46:47], v[46:47], v[22:23]
    v_pk_add_f32 v[48:49], v[48:49], v[24:25]
    v_pk_add_f32 v[50:51], v[50:51], v[26:27]
    v_pk_add_f32 v[52:53], v[52:53], v[28:29]
    v_pk_add_f32 v[54:55], v[54:55], v[30:31]
    v_lshlrev_b32 v16, 16, v80
    v_and_b32 v17, 0xffff0000, v80
    v_lshlrev_b32 v18, 16, v81
    v_and_b32 v19, 0xffff0000, v81
    v_lshlrev_b32 v20, 16, v82
    v_and_b32 v21, 0xffff0000, v82
    v_lshlrev_b32 v22, 16, v83
    v_and_b32 v23, 0xffff0000, v83
    v_lshlrev_b32 v24, 16, v84
    v_and_b32 v25, 0xffff0000, v84
    v_lshlrev_b32 v26, 16, v85
    v_and_b32 v27, 0xffff0000, v85
    v_lshlrev_b32 v28, 16, v86
    v_and_b32 v29, 0xffff0000, v86
    v_lshlrev_b32 v30, 16, v87
    v_and_b32 v31, 0xffff0000, v87
    v_pk_add_f32 v[56:57], v[56:57], v[16:17]
    v_pk_add_f32 v[58:59], v[58:59], v[18:19]
    v_pk_add_f32 v[60:61], v[60:61], v[20:21]
    v_pk_add_f32 v[62:63], v[62:63], v[22:23]
    v_pk_add_f32 v[64:65], v[64:65], v[24:25]
    v_pk_add_f32 v[66:67], v[66:67], v[26:27]
    v_pk_add_f32 v[68:69], v[68:69], v[28:29]
    v_pk_add_f32 v[70:71], v[70:71], v[30:31]
    v_cvt_pk_bf16_f32 v72, v40, v41
    v_cvt_pk_bf16_f32 v73, v42, v43
    v_cvt_pk_bf16_f32 v74, v44, v45
    v_cvt_pk_bf16_f32 v75, v46, v47
    v_cvt_pk_bf16_f32 v76, v48, v49
    v_cvt_pk_bf16_f32 v77, v50, v51
    v_cvt_pk_bf16_f32 v78, v52, v53
    v_cvt_pk_bf16_f32 v79, v54, v55
    v_cvt_pk_bf16_f32 v80, v56, v57
    v_cvt_pk_bf16_f32 v81, v58, v59
    v_cvt_pk_bf16_f32 v82, v60, v61
    v_cvt_pk_bf16_f32 v83, v62, v63
    v_cvt_pk_bf16_f32 v84, v64, v65
    v_cvt_pk_bf16_f32 v85, v66, v67
    v_cvt_pk_bf16_f32 v86, v68, v69
    v_cvt_pk_bf16_f32 v87, v70, v71
    buffer_store_dwordx2 v[72:73], v88, s[12:15], 0 offen sc1
    buffer_store_dwordx2 v[74:75], v89, s[12:15], 0 offen sc1
    buffer_store_dwordx2 v[76:77], v90, s[12:15], 0 offen sc1
    buffer_store_dwordx2 v[78:79], v91, s[12:15], 0 offen sc1
    buffer_store_dwordx2 v[80:81], v88, s[12:15], s48 offen sc1
    buffer_store_dwordx2 v[82:83], v89, s[12:15], s48 offen sc1
    buffer_store_dwordx2 v[84:85], v90, s[12:15], s48 offen sc1
    buffer_store_dwordx2 v[86:87], v91, s[12:15], s48 offen sc1
    v_pk_add_f32 v[18:19], v[40:41], v[42:43]
    v_pk_add_f32 v[20:21], v[44:45], v[46:47]
    v_pk_add_f32 v[18:19], v[18:19], v[48:49]
    v_pk_add_f32 v[20:21], v[20:21], v[50:51]
    v_pk_add_f32 v[18:19], v[18:19], v[52:53]
    v_pk_add_f32 v[20:21], v[20:21], v[54:55]
    v_pk_add_f32 v[18:19], v[18:19], v[56:57]
    v_pk_add_f32 v[20:21], v[20:21], v[58:59]
    v_pk_add_f32 v[18:19], v[18:19], v[60:61]
    v_pk_add_f32 v[20:21], v[20:21], v[62:63]
    v_pk_add_f32 v[18:19], v[18:19], v[64:65]
    v_pk_add_f32 v[20:21], v[20:21], v[66:67]
    v_pk_add_f32 v[18:19], v[18:19], v[68:69]
    v_pk_add_f32 v[20:21], v[20:21], v[70:71]
    v_pk_add_f32 v[18:19], v[18:19], v[20:21]
    v_add_f32 v16, v18, v19
    v_mov_b32 v17, v16
    s_nop 1
    v_permlane32_swap_b32 v16, v17
    s_nop 1
    v_add_f32 v16, v16, v17
    v_mul_f32 v18, 0x3c800000, v16
    v_pk_add_f32 v[40:41], v[40:41], v[18:19] op_sel_hi:[1,0] neg_lo:[0,1] neg_hi:[0,1]
    v_pk_add_f32 v[42:43], v[42:43], v[18:19] op_sel_hi:[1,0] neg_lo:[0,1] neg_hi:[0,1]
    v_pk_add_f32 v[44:45], v[44:45], v[18:19] op_sel_hi:[1,0] neg_lo:[0,1] neg_hi:[0,1]
    v_pk_add_f32 v[46:47], v[46:47], v[18:19] op_sel_hi:[1,0] neg_lo:[0,1] neg_hi:[0,1]
    v_pk_add_f32 v[48:49], v[48:49], v[18:19] op_sel_hi:[1,0] neg_lo:[0,1] neg_hi:[0,1]
    v_pk_add_f32 v[50:51], v[50:51], v[18:19] op_sel_hi:[1,0] neg_lo:[0,1] neg_hi:[0,1]
    v_pk_add_f32 v[52:53], v[52:53], v[18:19] op_sel_hi:[1,0] neg_lo:[0,1] neg_hi:[0,1]
    v_pk_add_f32 v[54:55], v[54:55], v[18:19] op_sel_hi:[1,0] neg_lo:[0,1] neg_hi:[0,1]
    v_pk_add_f32 v[56:57], v[56:57], v[18:19] op_sel_hi:[1,0] neg_lo:[0,1] neg_hi:[0,1]
    v_pk_add_f32 v[58:59], v[58:59], v[18:19] op_sel_hi:[1,0] neg_lo:[0,1] neg_hi:[0,1]
    v_pk_add_f32 v[60:61], v[60:61], v[18:19] op_sel_hi:[1,0] neg_lo:[0,1] neg_hi:[0,1]
    v_pk_add_f32 v[62:63], v[62:63], v[18:19] op_sel_hi:[1,0] neg_lo:[0,1] neg_hi:[0,1]
    v_pk_add_f32 v[64:65], v[64:65], v[18:19] op_sel_hi:[1,0] neg_lo:[0,1] neg_hi:[0,1]
    v_pk_add_f32 v[66:67], v[66:67], v[18:19] op_sel_hi:[1,0] neg_lo:[0,1] neg_hi:[0,1]
    v_pk_add_f32 v[68:69], v[68:69], v[18:19] op_sel_hi:[1,0] neg_lo:[0,1] neg_hi:[0,1]
    v_pk_add_f32 v[70:71], v[70:71], v[18:19] op_sel_hi:[1,0] neg_lo:[0,1] neg_hi:[0,1]
    v_pk_mul_f32 v[20:21], v[40:41], v[40:41]
    v_pk_mul_f32 v[22:23], v[42:43], v[42:43]
    v_pk_fma_f32 v[20:21], v[44:45], v[44:45], v[20:21]
    v_pk_fma_f32 v[22:23], v[46:47], v[46:47], v[22:23]
    v_pk_fma_f32 v[20:21], v[48:49], v[48:49], v[20:21]
    v_pk_fma_f32 v[22:23], v[50:51], v[50:51], v[22:23]
    v_pk_fma_f32 v[20:21], v[52:53], v[52:53], v[20:21]
    v_pk_fma_f32 v[22:23], v[54:55], v[54:55], v[22:23]
    v_pk_fma_f32 v[20:21], v[56:57], v[56:57], v[20:21]
    v_pk_fma_f32 v[22:23], v[58:59], v[58:59], v[22:23]
    v_pk_fma_f32 v[20:21], v[60:61], v[60:61], v[20:21]
    v_pk_fma_f32 v[22:23], v[62:63], v[62:63], v[22:23]
    v_pk_fma_f32 v[20:21], v[64:65], v[64:65], v[20:21]
    v_pk_fma_f32 v[22:23], v[66:67], v[66:67], v[22:23]
    v_pk_fma_f32 v[20:21], v[68:69], v[68:69], v[20:21]
    v_pk_fma_f32 v[22:23], v[70:71], v[70:71], v[22:23]
    v_pk_add_f32 v[20:21], v[20:21], v[22:23]
    v_add_f32 v17, v20, v21
    v_mov_b32 v19, v17
    s_nop 1
    v_permlane32_swap_b32 v17, v19
    s_nop 1
    v_add_f32 v17, v17, v19
    v_cmp_gt_u32 vcc, 32, v2
    s_and_saveexec_b64 s[50:51], vcc
    buffer_store_dwordx2 v[16:17], v93, s[16:19], 0 offen
    s_mov_b64 exec, s[50:51]
    s_waitcnt vmcnt(0)
END_k2_wo_kernel_1:
    s_endpgm

.globl k3_gateup_kernel
.p2align 8
.type k3_gateup_kernel,@function
k3_gateup_kernel:
Lcode_k3_gateup_kernel:
    s_cmp_ge_u32 s2, 256
    s_cbranch_scc1 END_k3_gateup_kernel_1
    s_load_dwordx2 s[28:29], s[0:1], 88
    s_load_dwordx2 s[8:9], s[0:1], 48
    s_load_dwordx2 s[10:11], s[0:1], 56
    v_lshrrev_b32 v1, 6, v0
    v_and_b32 v2, 63, v0
    s_and_b32 s30, s2, 7
    s_lshr_b32 s31, s2, 3
    s_and_b32 s32, s30, 1
    s_lshl_b32 s32, s32, 2
    s_and_b32 s34, s31, 3
    s_add_u32 s34, s34, s32
    s_lshr_b32 s32, s30, 1
    s_lshl_b32 s32, s32, 3
    s_lshr_b32 s35, s31, 2
    s_add_u32 s35, s35, s32
    v_readfirstlane_b32 s33, v1
    s_lshl_b32 s40, s34, 19
    s_lshl_b32 s56, s33, 12
    v_lshlrev_b32 v10, 4, v2
    v_add_u32 v4, s56, v10
    s_mov_b32 s41, 0
    s_mov_b32 s42, 0
    s_mov_b32 s43, 0
    s_mov_b32 s57, 0x7ff00000
    s_and_b32 s37, s33, 1
    s_lshl_b32 s37, s37, 2
    s_mul_i32 s38, s35, 224
    s_add_u32 s39, s37, 0
    s_min_u32 s39, s39, 6
    s_lshl_b32 s52, s39, 10
    s_lshl_b32 s39, s39, 6
    v_add_u32 v10, s39, v2
    v_mul_u32_u24 v11, 4682, v10
    v_lshrrev_b32 v11, 16, v11
    v_mul_u32_u24 v12, 14, v11
    v_sub_u32 v12, v10, v12
    v_mul_u32_u24 v11, 7168, v11
    v_lshl_add_u32 v11, v12, 4, v11
    v_add_u32 v5, s38, v11
    s_add_u32 s39, s37, 1
    s_min_u32 s39, s39, 6
    s_lshl_b32 s53, s39, 10
    s_lshl_b32 s39, s39, 6
    v_add_u32 v10, s39, v2
    v_mul_u32_u24 v11, 4682, v10
    v_lshrrev_b32 v11, 16, v11
    v_mul_u32_u24 v12, 14, v11
    v_sub_u32 v12, v10, v12
    v_mul_u32_u24 v11, 7168, v11
    v_lshl_add_u32 v11, v12, 4, v11
    v_add_u32 v6, s38, v11
    s_add_u32 s39, s37, 2
    s_min_u32 s39, s39, 6
    s_lshl_b32 s54, s39, 10
    s_lshl_b32 s39, s39, 6
    v_add_u32 v10, s39, v2
    v_mul_u32_u24 v11, 4682, v10
    v_lshrrev_b32 v11, 16, v11
    v_mul_u32_u24 v12, 14, v11
    v_sub_u32 v12, v10, v12
    v_mul_u32_u24 v11, 7168, v11
    v_lshl_add_u32 v11, v12, 4, v11
    v_add_u32 v7, s38, v11
    s_add_u32 s39, s37, 3
    s_min_u32 s39, s39, 6
    s_lshl_b32 s55, s39, 10
    s_lshl_b32 s39, s39, 6
    v_add_u32 v10, s39, v2
    v_mul_u32_u24 v11, 4682, v10
    v_lshrrev_b32 v11, 16, v11
    v_mul_u32_u24 v12, 14, v11
    v_sub_u32 v12, v10, v12
    v_mul_u32_u24 v11, 7168, v11
    v_lshl_add_u32 v11, v12, 4, v11
    v_add_u32 v8, s38, v11
    s_lshr_b32 s39, s33, 1
    s_mul_i32 s39, s39, 7168
    s_add_u32 s39, s39, 16384
    s_add_u32 s52, s52, s39
    s_add_u32 s53, s53, s39
    s_add_u32 s54, s54, s39
    s_add_u32 s55, s55, s39
    s_waitcnt lgkmcnt(0)
    s_cmp_ge_u32 s33, 2
    s_cselect_b32 s8, s10, s8
    s_cselect_b32 s9, s11, s9
    s_mov_b32 s10, 7340032
    s_mov_b32 s11, 0x20000
    s_add_u32 s4, s28, 9437184
    s_addc_u32 s5, s29, 0
    s_mov_b32 s6, 4194304
    s_mov_b32 s7, 0x20000
    s_cmp_lt_u32 s43, 32
    s_cselect_b32 s44, s40, s57
    s_cselect_b32 s45, s41, s57
    s_add_u32 m0, s42, s56
    s_add_u32 s43, s43, 1
    buffer_load_dwordx4 v4, s[4:7], s44 offen lds
    buffer_load_dwordx4 v4, s[4:7], s44 offen offset:1024 lds
    buffer_load_dwordx4 v4, s[4:7], s44 offen offset:2048 lds
    buffer_load_dwordx4 v4, s[4:7], s44 offen offset:3072 lds
    s_add_u32 m0, s42, s52
    s_nop 0
    buffer_load_dwordx4 v5, s[8:11], s45 offen lds
    s_add_u32 m0, s42, s53
    s_nop 0
    buffer_load_dwordx4 v6, s[8:11], s45 offen lds
    s_add_u32 m0, s42, s54
    s_nop 0
    buffer_load_dwordx4 v7, s[8:11], s45 offen lds
    s_add_u32 m0, s42, s55
    s_nop 0
    buffer_load_dwordx4 v8, s[8:11], s45 offen lds
    s_add_u32 s40, s40, 16384
    s_add_u32 s41, s41, 229376
    s_add_u32 s42, s42, 30720
    s_cmp_eq_u32 s42, 153600
    s_cselect_b32 s42, 0, s42
    s_cmp_lt_u32 s43, 32
    s_cselect_b32 s44, s40, s57
    s_cselect_b32 s45, s41, s57
    s_add_u32 m0, s42, s56
    s_add_u32 s43, s43, 1
    buffer_load_dwordx4 v4, s[4:7], s44 offen lds
    buffer_load_dwordx4 v4, s[4:7], s44 offen offset:1024 lds
    buffer_load_dwordx4 v4, s[4:7], s44 offen offset:2048 lds
    buffer_load_dwordx4 v4, s[4:7], s44 offen offset:3072 lds
    s_add_u32 m0, s42, s52
    s_nop 0
    buffer_load_dwordx4 v5, s[8:11], s45 offen lds
    s_add_u32 m0, s42, s53
    s_nop 0
    buffer_load_dwordx4 v6, s[8:11], s45 offen lds
    s_add_u32 m0, s42, s54
    s_nop 0
    buffer_load_dwordx4 v7, s[8:11], s45 offen lds
    s_add_u32 m0, s42, s55
    s_nop 0
    buffer_load_dwordx4 v8, s[8:11], s45 offen lds
    s_add_u32 s40, s40, 16384
    s_add_u32 s41, s41, 229376
    s_add_u32 s42, s42, 30720
    s_cmp_eq_u32 s42, 153600
    s_cselect_b32 s42, 0, s42
    s_add_u32 s12, s28, 13631488
    s_addc_u32 s13, s29, 0
    s_mov_b32 s14, 262144
    s_mov_b32 s15, 0x20000
    s_add_u32 s16, s28, 14155776
    s_addc_u32 s17, s29, 0
    s_mov_b32 s18, 114688
    s_mov_b32 s19, 0x20000
    s_add_u32 s20, s28, 14680064
    s_addc_u32 s21, s29, 0
    s_mov_b32 s22, 14680064
    s_mov_b32 s23, 0x20000
    s_lshl_b32 s36, s34, 11
    v_lshlrev_b32 v3, 3, v0
    v_min_u32 v11, 223, v0
    v_cmp_le_u32 vcc, 112, v11
    v_mov_b32 v13, 3472
    v_mov_b32 v12, 0
    v_cndmask_b32 v12, v12, v13, vcc
    v_add_u32 v12, v12, v11
    s_mul_i32 s37, s35, 112
    v_add_u32 v12, s37, v12
    v_lshlrev_b32 v28, 2, v12
    v_mov_b32 v9, v4
    v_lshrrev_b32 v10, 2, v2
    v_mul_u32_u24 v10, 224, v10
    v_and_b32 v11, 3, v2
    v_lshl_add_u32 v10, v11, 3, v10
    v_add_u32 v10, 16384, v10
    s_waitcnt vmcnt(8)
    s_barrier
    ds_read_b128 a[0:3], v9 offset:0
    ds_read_b128 a[4:7], v9 offset:1024
    ds_read_b128 a[8:11], v9 offset:2048
    ds_read_b128 a[12:15], v9 offset:3072
    ds_read_b64_tr_b16 a[32:33], v10 offset:0
    ds_read_b64_tr_b16 a[34:35], v10 offset:3584
    ds_read_b64_tr_b16 a[36:37], v10 offset:32
    ds_read_b64_tr_b16 a[38:39], v10 offset:3616
    ds_read_b64_tr_b16 a[40:41], v10 offset:64
    ds_read_b64_tr_b16 a[42:43], v10 offset:3648
    ds_read_b64_tr_b16 a[44:45], v10 offset:96
    ds_read_b64_tr_b16 a[46:47], v10 offset:3680
    ds_read_b64_tr_b16 a[48:49], v10 offset:128
    ds_read_b64_tr_b16 a[50:51], v10 offset:3712
    ds_read_b64_tr_b16 a[52:53], v10 offset:160
    ds_read_b64_tr_b16 a[54:55], v10 offset:3744
    s_waitcnt lgkmcnt(4)
    ds_read_b64_tr_b16 a[56:57], v10 offset:192
    ds_read_b64_tr_b16 a[58:59], v10 offset:3776
    ds_read_b64_tr_b16 a[60:61], v10 offset:7168
    ds_read_b64_tr_b16 a[62:63], v10 offset:10752
    ds_read_b64_tr_b16 a[64:65], v10 offset:7200
    ds_read_b64_tr_b16 a[66:67], v10 offset:10784
    ds_read_b64_tr_b16 a[68:69], v10 offset:7232
    ds_read_b64_tr_b16 a[70:71], v10 offset:10816
    ds_read_b64_tr_b16 a[72:73], v10 offset:7264
    ds_read_b64_tr_b16 a[74:75], v10 offset:10848
    ds_read_b64_tr_b16 a[76:77], v10 offset:7296
    ds_read_b64_tr_b16 a[78:79], v10 offset:10880
    ds_read_b64_tr_b16 a[80:81], v10 offset:7328
    ds_read_b64_tr_b16 a[82:83], v10 offset:10912
    ds_read_b64_tr_b16 a[84:85], v10 offset:7360
    ds_read_b64_tr_b16 a[86:87], v10 offset:10944
    buffer_load_dwordx2 a[88:89], v3, s[12:15], s36 offen
    s_add_u32 s36, s36, 16384
    buffer_load_dwordx2 a[90:91], v3, s[12:15], s36 offen
    s_add_u32 s36, s36, 16384
    buffer_load_dwordx2 a[92:93], v3, s[12:15], s36 offen
    s_add_u32 s36, s36, 16384
    buffer_load_dwordx2 a[94:95], v3, s[12:15], s36 offen
    s_add_u32 s36, s36, 16384
    buffer_load_dwordx2 a[96:97], v3, s[12:15], s36 offen
    s_add_u32 s36, s36, 16384
    buffer_load_dwordx2 a[98:99], v3, s[12:15], s36 offen
    s_add_u32 s36, s36, 16384
    buffer_load_dwordx2 a[100:101], v3, s[12:15], s36 offen
    s_add_u32 s36, s36, 16384
    buffer_load_dwordx2 a[102:103], v3, s[12:15], s36 offen
    s_add_u32 s36, s36, 16384
    buffer_load_dwordx2 a[104:105], v3, s[12:15], s36 offen
    s_add_u32 s36, s36, 16384
    buffer_load_dwordx2 a[106:107], v3, s[12:15], s36 offen
    s_add_u32 s36, s36, 16384
    buffer_load_dwordx2 a[108:109], v3, s[12:15], s36 offen
    s_add_u32 s36, s36, 16384
    buffer_load_dwordx2 a[110:111], v3, s[12:15], s36 offen
    s_add_u32 s36, s36, 16384
    buffer_load_dwordx2 a[112:113], v3, s[12:15], s36 offen
    s_add_u32 s36, s36, 16384
    buffer_load_dwordx2 a[114:115], v3, s[12:15], s36 offen
    s_add_u32 s36, s36, 16384
    buffer_load_dwordx2 a[116:117], v3, s[12:15], s36 offen
    s_add_u32 s36, s36, 16384
    buffer_load_dwordx2 a[118:119], v3, s[12:15], s36 offen
    s_mov_b32 s39, 0
    buffer_load_dword v24, v28, s[16:19], s39 offen
    s_mov_b32 s39, 28672
    buffer_load_dword v25, v28, s[16:19], s39 offen
    s_mov_b32 s39, 57344
    buffer_load_dword v26, v28, s[16:19], s39 offen
    s_mov_b32 s39, 86016
    buffer_load_dword v27, v28, s[16:19], s39 offen
    s_mov_b32 s46, 30720
    s_mov_b32 s38, 30720
    s_waitcnt lgkmcnt(0)
    v_mfma_f32_16x16x32_bf16 v[32:35], a[32:35], a[0:3], 0
    v_add_u32 v9, s38, v9
    v_mfma_f32_16x16x32_bf16 v[36:39], a[32:35], a[4:7], 0
    v_add_u32 v10, s38, v10
    v_mfma_f32_16x16x32_bf16 v[40:43], a[32:35], a[8:11], 0
    s_waitcnt vmcnt(20)
    v_mfma_f32_16x16x32_bf16 v[44:47], a[32:35], a[12:15], 0
    s_barrier
    ds_read_b64_tr_b16 a[32:33], v10 offset:0
    v_mfma_f32_16x16x32_bf16 v[48:51], a[36:39], a[0:3], 0
    ds_read_b64_tr_b16 a[34:35], v10 offset:3584
    v_mfma_f32_16x16x32_bf16 v[52:55], a[36:39], a[4:7], 0
    ds_read_b128 a[16:19], v9 offset:0
    s_cmp_lt_u32 s43, 32
    s_cselect_b32 s44, s40, s57
    v_mfma_f32_16x16x32_bf16 v[56:59], a[36:39], a[8:11], 0
    ds_read_b128 a[20:23], v9 offset:1024
    s_cselect_b32 s45, s41, s57
    s_add_u32 m0, s42, s56
    v_mfma_f32_16x16x32_bf16 v[60:63], a[36:39], a[12:15], 0
    ds_read_b64_tr_b16 a[36:37], v10 offset:32
    v_mfma_f32_16x16x32_bf16 v[64:67], a[40:43], a[0:3], 0
    ds_read_b64_tr_b16 a[38:39], v10 offset:3616
    v_mfma_f32_16x16x32_bf16 v[68:71], a[40:43], a[4:7], 0
    ds_read_b128 a[24:27], v9 offset:2048
    buffer_load_dwordx4 v4, s[4:7], s44 offen lds
    v_mfma_f32_16x16x32_bf16 v[72:75], a[40:43], a[8:11], 0
    ds_read_b128 a[28:31], v9 offset:3072
    buffer_load_dwordx4 v4, s[4:7], s44 offen offset:1024 lds
    v_mfma_f32_16x16x32_bf16 v[76:79], a[40:43], a[12:15], 0
    ds_read_b64_tr_b16 a[40:41], v10 offset:64
    v_mfma_f32_16x16x32_bf16 v[80:83], a[44:47], a[0:3], 0
    ds_read_b64_tr_b16 a[42:43], v10 offset:3648
    buffer_load_dwordx4 v4, s[4:7], s44 offen offset:2048 lds
    v_mfma_f32_16x16x32_bf16 v[84:87], a[44:47], a[4:7], 0
    buffer_load_dwordx4 v4, s[4:7], s44 offen offset:3072 lds
    s_add_u32 m0, s42, s52
    v_mfma_f32_16x16x32_bf16 v[88:91], a[44:47], a[8:11], 0
    buffer_load_dwordx4 v5, s[8:11], s45 offen lds
    s_add_u32 m0, s42, s53
    v_mfma_f32_16x16x32_bf16 v[92:95], a[44:47], a[12:15], 0
    ds_read_b64_tr_b16 a[44:45], v10 offset:96
    v_mfma_f32_16x16x32_bf16 v[96:99], a[48:51], a[0:3], 0
    ds_read_b64_tr_b16 a[46:47], v10 offset:3680
    buffer_load_dwordx4 v6, s[8:11], s45 offen lds
    s_add_u32 m0, s42, s54
    v_mfma_f32_16x16x32_bf16 v[100:103], a[48:51], a[4:7], 0
    buffer_load_dwordx4 v7, s[8:11], s45 offen lds
    s_add_u32 m0, s42, s55
    v_mfma_f32_16x16x32_bf16 v[104:107], a[48:51], a[8:11], 0
    buffer_load_dwordx4 v8, s[8:11], s45 offen lds
    v_mfma_f32_16x16x32_bf16 v[108:111], a[48:51], a[12:15], 0
    ds_read_b64_tr_b16 a[48:49], v10 offset:128
    v_mfma_f32_16x16x32_bf16 v[112:115], a[52:55], a[0:3], 0
    ds_read_b64_tr_b16 a[50:51], v10 offset:3712
    s_add_u32 s43, s43, 1
    s_add_u32 s40, s40, 16384
    v_mfma_f32_16x16x32_bf16 v[116:119], a[52:55], a[4:7], 0
    s_add_u32 s41, s41, 229376
    s_add_u32 s42, s42, 30720
    v_mfma_f32_16x16x32_bf16 v[120:123], a[52:55], a[8:11], 0
    s_waitcnt lgkmcnt(4)
    v_mfma_f32_16x16x32_bf16 v[124:127], a[52:55], a[12:15], 0
    ds_read_b64_tr_b16 a[52:53], v10 offset:160
    v_mfma_f32_16x16x32_bf16 v[128:131], a[56:59], a[0:3], 0
    ds_read_b64_tr_b16 a[54:55], v10 offset:3744
    s_cmp_eq_u32 s42, 153600
    s_cselect_b32 s42, 0, s42
    v_mfma_f32_16x16x32_bf16 v[132:135], a[56:59], a[4:7], 0
    s_cmp_lt_u32 s43, 32
    s_cselect_b32 s44, s40, s57
    v_mfma_f32_16x16x32_bf16 v[136:139], a[56:59], a[8:11], 0
    s_cselect_b32 s45, s41, s57
    s_add_u32 m0, s42, s56
    v_mfma_f32_16x16x32_bf16 v[140:143], a[56:59], a[12:15], 0
    ds_read_b64_tr_b16 a[56:57], v10 offset:192
    v_mfma_f32_16x16x32_bf16 v[144:147], a[60:63], a[0:3], 0
    ds_read_b64_tr_b16 a[58:59], v10 offset:3776
    buffer_load_dwordx4 v4, s[4:7], s44 offen lds
    v_mfma_f32_16x16x32_bf16 v[148:151], a[60:63], a[4:7], 0
    buffer_load_dwordx4 v4, s[4:7], s44 offen offset:1024 lds
    v_mfma_f32_16x16x32_bf16 v[152:155], a[60:63], a[8:11], 0
    buffer_load_dwordx4 v4, s[4:7], s44 offen offset:2048 lds
    v_mfma_f32_16x16x32_bf16 v[156:159], a[60:63], a[12:15], 0
    ds_read_b64_tr_b16 a[60:61], v10 offset:7168
    v_mfma_f32_16x16x32_bf16 v[160:163], a[64:67], a[0:3], 0
    ds_read_b64_tr_b16 a[62:63], v10 offset:10752
    buffer_load_dwordx4 v4, s[4:7], s44 offen offset:3072 lds
    s_add_u32 m0, s42, s52
    v_mfma_f32_16x16x32_bf16 v[164:167], a[64:67], a[4:7], 0
    buffer_load_dwordx4 v5, s[8:11], s45 offen lds
    s_add_u32 m0, s42, s53
    v_mfma_f32_16x16x32_bf16 v[168:171], a[64:67], a[8:11], 0
    buffer_load_dwordx4 v6, s[8:11], s45 offen lds
    s_add_u32 m0, s42, s54
    v_mfma_f32_16x16x32_bf16 v[172:175], a[64:67], a[12:15], 0
    ds_read_b64_tr_b16 a[64:65], v10 offset:7200
    v_mfma_f32_16x16x32_bf16 v[176:179], a[68:71], a[0:3], 0
    ds_read_b64_tr_b16 a[66:67], v10 offset:10784
    buffer_load_dwordx4 v7, s[8:11], s45 offen lds
    s_add_u32 m0, s42, s55
    v_mfma_f32_16x16x32_bf16 v[180:183], a[68:71], a[4:7], 0
    buffer_load_dwordx4 v8, s[8:11], s45 offen lds
    v_mfma_f32_16x16x32_bf16 v[184:187], a[68:71], a[8:11], 0
    v_mfma_f32_16x16x32_bf16 v[188:191], a[68:71], a[12:15], 0
    ds_read_b64_tr_b16 a[68:69], v10 offset:7232
    v_mfma_f32_16x16x32_bf16 v[192:195], a[72:75], a[0:3], 0
    ds_read_b64_tr_b16 a[70:71], v10 offset:10816
    s_add_u32 s43, s43, 1
    s_add_u32 s40, s40, 16384
    v_mfma_f32_16x16x32_bf16 v[196:199], a[72:75], a[4:7], 0
    s_add_u32 s41, s41, 229376
    s_add_u32 s42, s42, 30720
    v_mfma_f32_16x16x32_bf16 v[200:203], a[72:75], a[8:11], 0
    s_cmp_eq_u32 s42, 153600
    s_cselect_b32 s42, 0, s42
    v_mfma_f32_16x16x32_bf16 v[204:207], a[72:75], a[12:15], 0
    ds_read_b64_tr_b16 a[72:73], v10 offset:7264
    v_mfma_f32_16x16x32_bf16 v[208:211], a[76:79], a[0:3], 0
    ds_read_b64_tr_b16 a[74:75], v10 offset:10848
    v_mfma_f32_16x16x32_bf16 v[212:215], a[76:79], a[4:7], 0
    v_mfma_f32_16x16x32_bf16 v[216:219], a[76:79], a[8:11], 0
    v_mfma_f32_16x16x32_bf16 v[220:223], a[76:79], a[12:15], 0
    ds_read_b64_tr_b16 a[76:77], v10 offset:7296
    v_mfma_f32_16x16x32_bf16 v[224:227], a[80:83], a[0:3], 0
    ds_read_b64_tr_b16 a[78:79], v10 offset:10880
    v_mfma_f32_16x16x32_bf16 v[228:231], a[80:83], a[4:7], 0
    s_add_u32 s37, s46, 30720
    s_cmp_eq_u32 s37, 153600
    v_mfma_f32_16x16x32_bf16 v[232:235], a[80:83], a[8:11], 0
    s_cselect_b32 s37, 0, s37
    s_sub_u32 s38, s37, s46
    v_mfma_f32_16x16x32_bf16 v[236:239], a[80:83], a[12:15], 0
    ds_read_b64_tr_b16 a[80:81], v10 offset:7328
    v_mfma_f32_16x16x32_bf16 v[240:243], a[84:87], a[0:3], 0
    ds_read_b64_tr_b16 a[82:83], v10 offset:10912
    v_mfma_f32_16x16x32_bf16 v[244:247], a[84:87], a[4:7], 0
    s_mov_b32 s46, s37
    v_mfma_f32_16x16x32_bf16 v[248:251], a[84:87], a[8:11], 0
    s_waitcnt lgkmcnt(4)
    v_mfma_f32_16x16x32_bf16 v[252:255], a[84:87], a[12:15], 0
    ds_read_b64_tr_b16 a[84:85], v10 offset:7360
    ds_read_b64_tr_b16 a[86:87], v10 offset:10944
    v_mfma_f32_16x16x32_bf16 v[32:35], a[32:35], a[16:19], v[32:35]
    v_add_u32 v9, s38, v9
    v_mfma_f32_16x16x32_bf16 v[36:39], a[32:35], a[20:23], v[36:39]
    v_add_u32 v10, s38, v10
    v_mfma_f32_16x16x32_bf16 v[40:43], a[32:35], a[24:27], v[40:43]
    s_waitcnt vmcnt(8)
    v_mfma_f32_16x16x32_bf16 v[44:47], a[32:35], a[28:31], v[44:47]
    s_barrier
    ds_read_b64_tr_b16 a[32:33], v10 offset:0
    v_mfma_f32_16x16x32_bf16 v[48:51], a[36:39], a[16:19], v[48:51]
    ds_read_b64_tr_b16 a[34:35], v10 offset:3584
    v_add_f32 v24, v24, v25
    v_add_f32 v26, v26, v27
    v_lshlrev_b32 v25, 2, v0
    v_mfma_f32_16x16x32_bf16 v[52:55], a[36:39], a[20:23], v[52:55]
    ds_read_b128 a[0:3], v9 offset:0
    s_cmp_lt_u32 s43, 32
    s_cselect_b32 s44, s40, s57
    v_add_f32 v24, v24, v26
    v_add_u32 v25, 157696, v25
    ds_write_b32 v25, v24
    v_mfma_f32_16x16x32_bf16 v[56:59], a[36:39], a[24:27], v[56:59]
    ds_read_b128 a[4:7], v9 offset:1024
    s_cselect_b32 s45, s41, s57
    s_add_u32 m0, s42, s56
    v_accvgpr_read_b32 v12, a88
    v_accvgpr_read_b32 v13, a90
    v_add_f32 v12, v12, v13
    v_mfma_f32_16x16x32_bf16 v[60:63], a[36:39], a[28:31], v[60:63]
    ds_read_b64_tr_b16 a[36:37], v10 offset:32
    v_accvgpr_read_b32 v13, a92
    v_add_f32 v12, v12, v13
    v_accvgpr_read_b32 v13, a94
    v_mfma_f32_16x16x32_bf16 v[64:67], a[40:43], a[16:19], v[64:67]
    ds_read_b64_tr_b16 a[38:39], v10 offset:3616
    v_add_f32 v12, v12, v13
    v_accvgpr_read_b32 v13, a96
    v_mfma_f32_16x16x32_bf16 v[68:71], a[40:43], a[20:23], v[68:71]
    ds_read_b128 a[8:11], v9 offset:2048
    buffer_load_dwordx4 v4, s[4:7], s44 offen lds
    v_add_f32 v12, v12, v13
    v_accvgpr_read_b32 v13, a98
    v_add_f32 v12, v12, v13
    v_mfma_f32_16x16x32_bf16 v[72:75], a[40:43], a[24:27], v[72:75]
    ds_read_b128 a[12:15], v9 offset:3072
    buffer_load_dwordx4 v4, s[4:7], s44 offen offset:1024 lds
    v_accvgpr_read_b32 v13, a100
    v_add_f32 v12, v12, v13
    v_accvgpr_read_b32 v13, a102
    v_mfma_f32_16x16x32_bf16 v[76:79], a[40:43], a[28:31], v[76:79]
    ds_read_b64_tr_b16 a[40:41], v10 offset:64
    v_add_f32 v12, v12, v13
    v_accvgpr_read_b32 v13, a104
    v_add_f32 v12, v12, v13
    v_mfma_f32_16x16x32_bf16 v[80:83], a[44:47], a[16:19], v[80:83]
    ds_read_b64_tr_b16 a[42:43], v10 offset:3648
    buffer_load_dwordx4 v4, s[4:7], s44 offen offset:2048 lds
    v_accvgpr_read_b32 v13, a106
    v_add_f32 v12, v12, v13
    v_mfma_f32_16x16x32_bf16 v[84:87], a[44:47], a[20:23], v[84:87]
    buffer_load_dwordx4 v4, s[4:7], s44 offen offset:3072 lds
    s_add_u32 m0, s42, s52
    v_accvgpr_read_b32 v13, a108
    v_add_f32 v12, v12, v13
    v_accvgpr_read_b32 v13, a110
    v_mfma_f32_16x16x32_bf16 v[88:91], a[44:47], a[24:27], v[88:91]
    buffer_load_dwordx4 v5, s[8:11], s45 offen lds
    s_add_u32 m0, s42, s53
    v_add_f32 v12, v12, v13
    v_accvgpr_read_b32 v13, a112
    v_add_f32 v12, v12, v13
    v_mfma_f32_16x16x32_bf16 v[92:95], a[44:47], a[28:31], v[92:95]
    ds_read_b64_tr_b16 a[44:45], v10 offset:96
    v_accvgpr_read_b32 v13, a114
    v_add_f32 v12, v12, v13
    v_accvgpr_read_b32 v13, a116
    v_mfma_f32_16x16x32_bf16 v[96:99], a[48:51], a[16:19], v[96:99]
    ds_read_b64_tr_b16 a[46:47], v10 offset:3680
    buffer_load_dwordx4 v6, s[8:11], s45 offen lds
    s_add_u32 m0, s42, s54
    v_add_f32 v12, v12, v13
    v_accvgpr_read_b32 v13, a118
    v_add_f32 v12, v12, v13
    v_mfma_f32_16x16x32_bf16 v[100:103], a[48:51], a[20:23], v[100:103]
    buffer_load_dwordx4 v7, s[8:11], s45 offen lds
    s_add_u32 m0, s42, s55
    v_mul_f32 v12, 0x3a800000, v12
    v_mov_b32 v16, 0x3c800000
    v_mfma_f32_16x16x32_bf16 v[104:107], a[48:51], a[24:27], v[104:107]
    buffer_load_dwordx4 v8, s[8:11], s45 offen lds
    v_mov_b32 v17, 0x42800000
    v_mov_b32 v14, 0
    v_mov_b32 v18, 0
    v_mfma_f32_16x16x32_bf16 v[108:111], a[48:51], a[28:31], v[108:111]
    ds_read_b64_tr_b16 a[48:49], v10 offset:128
    v_accvgpr_read_b32 v13, a88
    v_accvgpr_read_b32 v15, a89
    v_fma_f32 v13, v13, v16, -v12
    v_mfma_f32_16x16x32_bf16 v[112:115], a[52:55], a[16:19], v[112:115]
    ds_read_b64_tr_b16 a[50:51], v10 offset:3712
    s_add_u32 s43, s43, 1
    s_add_u32 s40, s40, 16384
    v_add_f32 v14, v14, v15
    v_fmac_f32 v18, v13, v13
    v_accvgpr_read_b32 v13, a90
    v_mfma_f32_16x16x32_bf16 v[116:119], a[52:55], a[20:23], v[116:119]
    s_add_u32 s41, s41, 229376
    s_add_u32 s42, s42, 30720
    v_accvgpr_read_b32 v15, a91
    v_fma_f32 v13, v13, v16, -v12
    v_mfma_f32_16x16x32_bf16 v[120:123], a[52:55], a[24:27], v[120:123]
    s_waitcnt lgkmcnt(0)
    v_add_f32 v14, v14, v15
    v_fmac_f32 v18, v13, v13
    v_accvgpr_read_b32 v13, a92
    v_mfma_f32_16x16x32_bf16 v[124:127], a[52:55], a[28:31], v[124:127]
    ds_read_b64_tr_b16 a[52:53], v10 offset:160
    v_accvgpr_read_b32 v15, a93
    v_fma_f32 v13, v13, v16, -v12
    v_add_f32 v14, v14, v15
    v_mfma_f32_16x16x32_bf16 v[128:131], a[56:59], a[16:19], v[128:131]
    ds_read_b64_tr_b16 a[54:55], v10 offset:3744
    s_cmp_eq_u32 s42, 153600
    s_cselect_b32 s42, 0, s42
    v_fmac_f32 v18, v13, v13
    v_accvgpr_read_b32 v13, a94
    v_accvgpr_read_b32 v15, a95
    v_mfma_f32_16x16x32_bf16 v[132:135], a[56:59], a[20:23], v[132:135]
    s_cmp_lt_u32 s43, 32
    s_cselect_b32 s44, s40, s57
    v_fma_f32 v13, v13, v16, -v12
    v_add_f32 v14, v14, v15
    v_fmac_f32 v18, v13, v13
    v_mfma_f32_16x16x32_bf16 v[136:139], a[56:59], a[24:27], v[136:139]
    s_cselect_b32 s45, s41, s57
    s_add_u32 m0, s42, s56
    v_accvgpr_read_b32 v13, a96
    v_accvgpr_read_b32 v15, a97
    v_mfma_f32_16x16x32_bf16 v[140:143], a[56:59], a[28:31], v[140:143]
    ds_read_b64_tr_b16 a[56:57], v10 offset:192
    v_fma_f32 v13, v13, v16, -v12
    v_add_f32 v14, v14, v15
    v_fmac_f32 v18, v13, v13
    v_mfma_f32_16x16x32_bf16 v[144:147], a[60:63], a[16:19], v[144:147]
    ds_read_b64_tr_b16 a[58:59], v10 offset:3776
    buffer_load_dwordx4 v4, s[4:7], s44 offen lds
    v_accvgpr_read_b32 v13, a98
    v_accvgpr_read_b32 v15, a99
    v_fma_f32 v13, v13, v16, -v12
    v_mfma_f32_16x16x32_bf16 v[148:151], a[60:63], a[20:23], v[148:151]
    buffer_load_dwordx4 v4, s[4:7], s44 offen offset:1024 lds
    v_add_f32 v14, v14, v15
    v_fmac_f32 v18, v13, v13
    v_accvgpr_read_b32 v13, a100
    v_mfma_f32_16x16x32_bf16 v[152:155], a[60:63], a[24:27], v[152:155]
    buffer_load_dwordx4 v4, s[4:7], s44 offen offset:2048 lds
    v_accvgpr_read_b32 v15, a101
    v_fma_f32 v13, v13, v16, -v12
    v_mfma_f32_16x16x32_bf16 v[156:159], a[60:63], a[28:31], v[156:159]
    ds_read_b64_tr_b16 a[60:61], v10 offset:7168
    v_add_f32 v14, v14, v15
    v_fmac_f32 v18, v13, v13
    v_accvgpr_read_b32 v13, a102
    v_mfma_f32_16x16x32_bf16 v[160:163], a[64:67], a[16:19], v[160:163]
    ds_read_b64_tr_b16 a[62:63], v10 offset:10752
    buffer_load_dwordx4 v4, s[4:7], s44 offen offset:3072 lds
    s_add_u32 m0, s42, s52
    v_accvgpr_read_b32 v15, a103
    v_fma_f32 v13, v13, v16, -v12
    v_add_f32 v14, v14, v15
    v_mfma_f32_16x16x32_bf16 v[164:167], a[64:67], a[20:23], v[164:167]
    buffer_load_dwordx4 v5, s[8:11], s45 offen lds
    s_add_u32 m0, s42, s53
    v_fmac_f32 v18, v13, v13
    v_accvgpr_read_b32 v13, a104
    v_accvgpr_read_b32 v15, a105
    v_mfma_f32_16x16x32_bf16 v[168:171], a[64:67], a[24:27], v[168:171]
    buffer_load_dwordx4 v6, s[8:11], s45 offen lds
    s_add_u32 m0, s42, s54
    v_fma_f32 v13, v13, v16, -v12
    v_add_f32 v14, v14, v15
    v_fmac_f32 v18, v13, v13
    v_mfma_f32_16x16x32_bf16 v[172:175], a[64:67], a[28:31], v[172:175]
    ds_read_b64_tr_b16 a[64:65], v10 offset:7200
    v_accvgpr_read_b32 v13, a106
    v_accvgpr_read_b32 v15, a107
    v_mfma_f32_16x16x32_bf16 v[176:179], a[68:71], a[16:19], v[176:179]
    ds_read_b64_tr_b16 a[66:67], v10 offset:10784
    buffer_load_dwordx4 v7, s[8:11], s45 offen lds
    s_add_u32 m0, s42, s55
    v_fma_f32 v13, v13, v16, -v12
    v_add_f32 v14, v14, v15
    v_fmac_f32 v18, v13, v13
    v_mfma_f32_16x16x32_bf16 v[180:183], a[68:71], a[20:23], v[180:183]
    buffer_load_dwordx4 v8, s[8:11], s45 offen lds
    v_accvgpr_read_b32 v13, a108
    v_accvgpr_read_b32 v15, a109
    v_fma_f32 v13, v13, v16, -v12
    v_mfma_f32_16x16x32_bf16 v[184:187], a[68:71], a[24:27], v[184:187]
    v_add_f32 v14, v14, v15
    v_fmac_f32 v18, v13, v13
    v_accvgpr_read_b32 v13, a110
    v_mfma_f32_16x16x32_bf16 v[188:191], a[68:71], a[28:31], v[188:191]
    ds_read_b64_tr_b16 a[68:69], v10 offset:7232
    v_accvgpr_read_b32 v15, a111
    v_fma_f32 v13, v13, v16, -v12
    v_mfma_f32_16x16x32_bf16 v[192:195], a[72:75], a[16:19], v[192:195]
    ds_read_b64_tr_b16 a[70:71], v10 offset:10816
    s_add_u32 s43, s43, 1
    s_add_u32 s40, s40, 16384
    v_add_f32 v14, v14, v15
    v_fmac_f32 v18, v13, v13
    v_accvgpr_read_b32 v13, a112
    v_mfma_f32_16x16x32_bf16 v[196:199], a[72:75], a[20:23], v[196:199]
    s_add_u32 s41, s41, 229376
    s_add_u32 s42, s42, 30720
    v_accvgpr_read_b32 v15, a113
    v_fma_f32 v13, v13, v16, -v12
    v_add_f32 v14, v14, v15
    v_mfma_f32_16x16x32_bf16 v[200:203], a[72:75], a[24:27], v[200:203]
    s_cmp_eq_u32 s42, 153600
    s_cselect_b32 s42, 0, s42
    v_fmac_f32 v18, v13, v13
    v_accvgpr_read_b32 v13, a114
    v_accvgpr_read_b32 v15, a115
    v_mfma_f32_16x16x32_bf16 v[204:207], a[72:75], a[28:31], v[204:207]
    ds_read_b64_tr_b16 a[72:73], v10 offset:7264
    v_fma_f32 v13, v13, v16, -v12
    v_add_f32 v14, v14, v15
    v_fmac_f32 v18, v13, v13
    v_mfma_f32_16x16x32_bf16 v[208:211], a[76:79], a[16:19], v[208:211]
    ds_read_b64_tr_b16 a[74:75], v10 offset:10848
    v_accvgpr_read_b32 v13, a116
    v_accvgpr_read_b32 v15, a117
    v_mfma_f32_16x16x32_bf16 v[212:215], a[76:79], a[20:23], v[212:215]
    v_fma_f32 v13, v13, v16, -v12
    v_add_f32 v14, v14, v15
    v_fmac_f32 v18, v13, v13
    v_mfma_f32_16x16x32_bf16 v[216:219], a[76:79], a[24:27], v[216:219]
    v_accvgpr_read_b32 v13, a118
    v_accvgpr_read_b32 v15, a119
    v_fma_f32 v13, v13, v16, -v12
    v_mfma_f32_16x16x32_bf16 v[220:223], a[76:79], a[28:31], v[220:223]
    ds_read_b64_tr_b16 a[76:77], v10 offset:7296
    v_add_f32 v14, v14, v15
    v_fmac_f32 v18, v13, v13
    v_fmac_f32 v14, v18, v17
    v_mfma_f32_16x16x32_bf16 v[224:227], a[80:83], a[16:19], v[224:227]
    ds_read_b64_tr_b16 a[78:79], v10 offset:10880
    v_mov_b32 v16, 0x3a800000
    v_mov_b32 v17, 0x3727c5ac
    v_mfma_f32_16x16x32_bf16 v[228:231], a[80:83], a[20:23], v[228:231]
    s_add_u32 s37, s46, 30720
    s_cmp_eq_u32 s37, 153600
    v_fma_f32 v14, v14, v16, v17
    v_rsq_f32 v15, v14
    v_sub_f32 v20, 0, v12
    v_mfma_f32_16x16x32_bf16 v[232:235], a[80:83], a[24:27], v[232:235]
    s_cselect_b32 s37, 0, s37
    s_sub_u32 s38, s37, s46
    v_mul_f32 v21, 0xc0135761, v15
    v_mul_f32 v22, v15, v15
    v_mul_f32 v22, v22, v15
    v_mfma_f32_16x16x32_bf16 v[236:239], a[80:83], a[28:31], v[236:239]
    ds_read_b64_tr_b16 a[80:81], v10 offset:7328
    v_mul_f32 v22, 0xbdd2d3e8, v22
    v_mov_b32 v23, v14
    v_lshlrev_b32 v13, 4, v0
    v_mfma_f32_16x16x32_bf16 v[240:243], a[84:87], a[16:19], v[240:243]
    ds_read_b64_tr_b16 a[82:83], v10 offset:10912
    v_add_u32 v13, 153600, v13
    ds_write_b128 v13, v[20:23]
    v_mfma_f32_16x16x32_bf16 v[244:247], a[84:87], a[20:23], v[244:247]
    s_mov_b32 s46, s37
    v_mfma_f32_16x16x32_bf16 v[248:251], a[84:87], a[24:27], v[248:251]
    s_waitcnt lgkmcnt(2)
    v_mfma_f32_16x16x32_bf16 v[252:255], a[84:87], a[28:31], v[252:255]
    ds_read_b64_tr_b16 a[84:85], v10 offset:7360
    ds_read_b64_tr_b16 a[86:87], v10 offset:10944
    s_mov_b32 s47, 15
MAIN_k3_gateup_kernel_2:
    v_mfma_f32_16x16x32_bf16 v[32:35], a[32:35], a[0:3], v[32:35]
    v_add_u32 v9, s38, v9
    v_mfma_f32_16x16x32_bf16 v[36:39], a[32:35], a[4:7], v[36:39]
    v_add_u32 v10, s38, v10
    v_mfma_f32_16x16x32_bf16 v[40:43], a[32:35], a[8:11], v[40:43]
    s_waitcnt vmcnt(16)
    v_mfma_f32_16x16x32_bf16 v[44:47], a[32:35], a[12:15], v[44:47]
    s_barrier
    ds_read_b64_tr_b16 a[32:33], v10 offset:0
    v_mfma_f32_16x16x32_bf16 v[48:51], a[36:39], a[0:3], v[48:51]
    ds_read_b64_tr_b16 a[34:35], v10 offset:3584
    v_mfma_f32_16x16x32_bf16 v[52:55], a[36:39], a[4:7], v[52:55]
    ds_read_b128 a[16:19], v9 offset:0
    v_mfma_f32_16x16x32_bf16 v[56:59], a[36:39], a[8:11], v[56:59]
    ds_read_b128 a[20:23], v9 offset:1024
    v_mfma_f32_16x16x32_bf16 v[60:63], a[36:39], a[12:15], v[60:63]
    ds_read_b64_tr_b16 a[36:37], v10 offset:32
    v_mfma_f32_16x16x32_bf16 v[64:67], a[40:43], a[0:3], v[64:67]
    ds_read_b64_tr_b16 a[38:39], v10 offset:3616
    v_mfma_f32_16x16x32_bf16 v[68:71], a[40:43], a[4:7], v[68:71]
    ds_read_b128 a[24:27], v9 offset:2048
    v_mfma_f32_16x16x32_bf16 v[72:75], a[40:43], a[8:11], v[72:75]
    ds_read_b128 a[28:31], v9 offset:3072
    v_mfma_f32_16x16x32_bf16 v[76:79], a[40:43], a[12:15], v[76:79]
    ds_read_b64_tr_b16 a[40:41], v10 offset:64
    v_mfma_f32_16x16x32_bf16 v[80:83], a[44:47], a[0:3], v[80:83]
    ds_read_b64_tr_b16 a[42:43], v10 offset:3648
    v_mfma_f32_16x16x32_bf16 v[84:87], a[44:47], a[4:7], v[84:87]
    s_cmp_lt_u32 s43, 32
    s_cselect_b32 s44, s40, s57
    v_mfma_f32_16x16x32_bf16 v[88:91], a[44:47], a[8:11], v[88:91]
    s_cselect_b32 s45, s41, s57
    s_add_u32 m0, s42, s56
    v_mfma_f32_16x16x32_bf16 v[92:95], a[44:47], a[12:15], v[92:95]
    ds_read_b64_tr_b16 a[44:45], v10 offset:96
    v_mfma_f32_16x16x32_bf16 v[96:99], a[48:51], a[0:3], v[96:99]
    ds_read_b64_tr_b16 a[46:47], v10 offset:3680
    v_mfma_f32_16x16x32_bf16 v[100:103], a[48:51], a[4:7], v[100:103]
    buffer_load_dwordx4 v4, s[4:7], s44 offen lds
    v_mfma_f32_16x16x32_bf16 v[104:107], a[48:51], a[8:11], v[104:107]
    buffer_load_dwordx4 v4, s[4:7], s44 offen offset:1024 lds
    v_mfma_f32_16x16x32_bf16 v[108:111], a[48:51], a[12:15], v[108:111]
    ds_read_b64_tr_b16 a[48:49], v10 offset:128
    v_mfma_f32_16x16x32_bf16 v[112:115], a[52:55], a[0:3], v[112:115]
    ds_read_b64_tr_b16 a[50:51], v10 offset:3712
    v_mfma_f32_16x16x32_bf16 v[116:119], a[52:55], a[4:7], v[116:119]
    buffer_load_dwordx4 v4, s[4:7], s44 offen offset:2048 lds
    v_mfma_f32_16x16x32_bf16 v[120:123], a[52:55], a[8:11], v[120:123]
    s_waitcnt lgkmcnt(4)
    v_mfma_f32_16x16x32_bf16 v[124:127], a[52:55], a[12:15], v[124:127]
    ds_read_b64_tr_b16 a[52:53], v10 offset:160
    v_mfma_f32_16x16x32_bf16 v[128:131], a[56:59], a[0:3], v[128:131]
    ds_read_b64_tr_b16 a[54:55], v10 offset:3744
    v_mfma_f32_16x16x32_bf16 v[132:135], a[56:59], a[4:7], v[132:135]
    buffer_load_dwordx4 v4, s[4:7], s44 offen offset:3072 lds
    v_mfma_f32_16x16x32_bf16 v[136:139], a[56:59], a[8:11], v[136:139]
    s_add_u32 m0, s42, s52
    v_mfma_f32_16x16x32_bf16 v[140:143], a[56:59], a[12:15], v[140:143]
    ds_read_b64_tr_b16 a[56:57], v10 offset:192
    v_mfma_f32_16x16x32_bf16 v[144:147], a[60:63], a[0:3], v[144:147]
    ds_read_b64_tr_b16 a[58:59], v10 offset:3776
    v_mfma_f32_16x16x32_bf16 v[148:151], a[60:63], a[4:7], v[148:151]
    buffer_load_dwordx4 v5, s[8:11], s45 offen lds
    v_mfma_f32_16x16x32_bf16 v[152:155], a[60:63], a[8:11], v[152:155]
    s_add_u32 m0, s42, s53
    v_mfma_f32_16x16x32_bf16 v[156:159], a[60:63], a[12:15], v[156:159]
    ds_read_b64_tr_b16 a[60:61], v10 offset:7168
    v_mfma_f32_16x16x32_bf16 v[160:163], a[64:67], a[0:3], v[160:163]
    ds_read_b64_tr_b16 a[62:63], v10 offset:10752
    v_mfma_f32_16x16x32_bf16 v[164:167], a[64:67], a[4:7], v[164:167]
    buffer_load_dwordx4 v6, s[8:11], s45 offen lds
    v_mfma_f32_16x16x32_bf16 v[168:171], a[64:67], a[8:11], v[168:171]
    s_add_u32 m0, s42, s54
    v_mfma_f32_16x16x32_bf16 v[172:175], a[64:67], a[12:15], v[172:175]
    ds_read_b64_tr_b16 a[64:65], v10 offset:7200
    v_mfma_f32_16x16x32_bf16 v[176:179], a[68:71], a[0:3], v[176:179]
    ds_read_b64_tr_b16 a[66:67], v10 offset:10784
    v_mfma_f32_16x16x32_bf16 v[180:183], a[68:71], a[4:7], v[180:183]
    buffer_load_dwordx4 v7, s[8:11], s45 offen lds
    v_mfma_f32_16x16x32_bf16 v[184:187], a[68:71], a[8:11], v[184:187]
    s_add_u32 m0, s42, s55
    v_mfma_f32_16x16x32_bf16 v[188:191], a[68:71], a[12:15], v[188:191]
    ds_read_b64_tr_b16 a[68:69], v10 offset:7232
    v_mfma_f32_16x16x32_bf16 v[192:195], a[72:75], a[0:3], v[192:195]
    ds_read_b64_tr_b16 a[70:71], v10 offset:10816
    v_mfma_f32_16x16x32_bf16 v[196:199], a[72:75], a[4:7], v[196:199]
    buffer_load_dwordx4 v8, s[8:11], s45 offen lds
    v_mfma_f32_16x16x32_bf16 v[200:203], a[72:75], a[8:11], v[200:203]
    s_add_u32 s43, s43, 1
    s_add_u32 s40, s40, 16384
    v_mfma_f32_16x16x32_bf16 v[204:207], a[72:75], a[12:15], v[204:207]
    ds_read_b64_tr_b16 a[72:73], v10 offset:7264
    v_mfma_f32_16x16x32_bf16 v[208:211], a[76:79], a[0:3], v[208:211]
    ds_read_b64_tr_b16 a[74:75], v10 offset:10848
    v_mfma_f32_16x16x32_bf16 v[212:215], a[76:79], a[4:7], v[212:215]
    s_add_u32 s41, s41, 229376
    s_add_u32 s42, s42, 30720
    v_mfma_f32_16x16x32_bf16 v[216:219], a[76:79], a[8:11], v[216:219]
    s_cmp_eq_u32 s42, 153600
    s_cselect_b32 s42, 0, s42
    v_mfma_f32_16x16x32_bf16 v[220:223], a[76:79], a[12:15], v[220:223]
    ds_read_b64_tr_b16 a[76:77], v10 offset:7296
    v_mfma_f32_16x16x32_bf16 v[224:227], a[80:83], a[0:3], v[224:227]
    ds_read_b64_tr_b16 a[78:79], v10 offset:10880
    v_mfma_f32_16x16x32_bf16 v[228:231], a[80:83], a[4:7], v[228:231]
    s_add_u32 s37, s46, 30720
    s_cmp_eq_u32 s37, 153600
    v_mfma_f32_16x16x32_bf16 v[232:235], a[80:83], a[8:11], v[232:235]
    s_cselect_b32 s37, 0, s37
    s_sub_u32 s38, s37, s46
    v_mfma_f32_16x16x32_bf16 v[236:239], a[80:83], a[12:15], v[236:239]
    ds_read_b64_tr_b16 a[80:81], v10 offset:7328
    v_mfma_f32_16x16x32_bf16 v[240:243], a[84:87], a[0:3], v[240:243]
    ds_read_b64_tr_b16 a[82:83], v10 offset:10912
    v_mfma_f32_16x16x32_bf16 v[244:247], a[84:87], a[4:7], v[244:247]
    s_mov_b32 s46, s37
    v_mfma_f32_16x16x32_bf16 v[248:251], a[84:87], a[8:11], v[248:251]
    s_waitcnt lgkmcnt(4)
    v_mfma_f32_16x16x32_bf16 v[252:255], a[84:87], a[12:15], v[252:255]
    ds_read_b64_tr_b16 a[84:85], v10 offset:7360
    ds_read_b64_tr_b16 a[86:87], v10 offset:10944
    v_mfma_f32_16x16x32_bf16 v[32:35], a[32:35], a[16:19], v[32:35]
    v_add_u32 v9, s38, v9
    v_mfma_f32_16x16x32_bf16 v[36:39], a[32:35], a[20:23], v[36:39]
    v_add_u32 v10, s38, v10
    v_mfma_f32_16x16x32_bf16 v[40:43], a[32:35], a[24:27], v[40:43]
    s_waitcnt vmcnt(16)
    v_mfma_f32_16x16x32_bf16 v[44:47], a[32:35], a[28:31], v[44:47]
    s_barrier
    ds_read_b64_tr_b16 a[32:33], v10 offset:0
    v_mfma_f32_16x16x32_bf16 v[48:51], a[36:39], a[16:19], v[48:51]
    ds_read_b64_tr_b16 a[34:35], v10 offset:3584
    v_mfma_f32_16x16x32_bf16 v[52:55], a[36:39], a[20:23], v[52:55]
    ds_read_b128 a[0:3], v9 offset:0
    v_mfma_f32_16x16x32_bf16 v[56:59], a[36:39], a[24:27], v[56:59]
    ds_read_b128 a[4:7], v9 offset:1024
    v_mfma_f32_16x16x32_bf16 v[60:63], a[36:39], a[28:31], v[60:63]
    ds_read_b64_tr_b16 a[36:37], v10 offset:32
    v_mfma_f32_16x16x32_bf16 v[64:67], a[40:43], a[16:19], v[64:67]
    ds_read_b64_tr_b16 a[38:39], v10 offset:3616
    v_mfma_f32_16x16x32_bf16 v[68:71], a[40:43], a[20:23], v[68:71]
    ds_read_b128 a[8:11], v9 offset:2048
    v_mfma_f32_16x16x32_bf16 v[72:75], a[40:43], a[24:27], v[72:75]
    ds_read_b128 a[12:15], v9 offset:3072
    v_mfma_f32_16x16x32_bf16 v[76:79], a[40:43], a[28:31], v[76:79]
    ds_read_b64_tr_b16 a[40:41], v10 offset:64
    v_mfma_f32_16x16x32_bf16 v[80:83], a[44:47], a[16:19], v[80:83]
    ds_read_b64_tr_b16 a[42:43], v10 offset:3648
    v_mfma_f32_16x16x32_bf16 v[84:87], a[44:47], a[20:23], v[84:87]
    s_cmp_lt_u32 s43, 32
    s_cselect_b32 s44, s40, s57
    v_mfma_f32_16x16x32_bf16 v[88:91], a[44:47], a[24:27], v[88:91]
    s_cselect_b32 s45, s41, s57
    s_add_u32 m0, s42, s56
    v_mfma_f32_16x16x32_bf16 v[92:95], a[44:47], a[28:31], v[92:95]
    ds_read_b64_tr_b16 a[44:45], v10 offset:96
    v_mfma_f32_16x16x32_bf16 v[96:99], a[48:51], a[16:19], v[96:99]
    ds_read_b64_tr_b16 a[46:47], v10 offset:3680
    v_mfma_f32_16x16x32_bf16 v[100:103], a[48:51], a[20:23], v[100:103]
    buffer_load_dwordx4 v4, s[4:7], s44 offen lds
    v_mfma_f32_16x16x32_bf16 v[104:107], a[48:51], a[24:27], v[104:107]
    buffer_load_dwordx4 v4, s[4:7], s44 offen offset:1024 lds
    v_mfma_f32_16x16x32_bf16 v[108:111], a[48:51], a[28:31], v[108:111]
    ds_read_b64_tr_b16 a[48:49], v10 offset:128
    v_mfma_f32_16x16x32_bf16 v[112:115], a[52:55], a[16:19], v[112:115]
    ds_read_b64_tr_b16 a[50:51], v10 offset:3712
    v_mfma_f32_16x16x32_bf16 v[116:119], a[52:55], a[20:23], v[116:119]
    buffer_load_dwordx4 v4, s[4:7], s44 offen offset:2048 lds
    v_mfma_f32_16x16x32_bf16 v[120:123], a[52:55], a[24:27], v[120:123]
    s_waitcnt lgkmcnt(4)
    v_mfma_f32_16x16x32_bf16 v[124:127], a[52:55], a[28:31], v[124:127]
    ds_read_b64_tr_b16 a[52:53], v10 offset:160
    v_mfma_f32_16x16x32_bf16 v[128:131], a[56:59], a[16:19], v[128:131]
    ds_read_b64_tr_b16 a[54:55], v10 offset:3744
    v_mfma_f32_16x16x32_bf16 v[132:135], a[56:59], a[20:23], v[132:135]
    buffer_load_dwordx4 v4, s[4:7], s44 offen offset:3072 lds
    v_mfma_f32_16x16x32_bf16 v[136:139], a[56:59], a[24:27], v[136:139]
    s_add_u32 m0, s42, s52
    v_mfma_f32_16x16x32_bf16 v[140:143], a[56:59], a[28:31], v[140:143]
    ds_read_b64_tr_b16 a[56:57], v10 offset:192
    v_mfma_f32_16x16x32_bf16 v[144:147], a[60:63], a[16:19], v[144:147]
    ds_read_b64_tr_b16 a[58:59], v10 offset:3776
    v_mfma_f32_16x16x32_bf16 v[148:151], a[60:63], a[20:23], v[148:151]
    buffer_load_dwordx4 v5, s[8:11], s45 offen lds
    v_mfma_f32_16x16x32_bf16 v[152:155], a[60:63], a[24:27], v[152:155]
    s_add_u32 m0, s42, s53
    v_mfma_f32_16x16x32_bf16 v[156:159], a[60:63], a[28:31], v[156:159]
    ds_read_b64_tr_b16 a[60:61], v10 offset:7168
    v_mfma_f32_16x16x32_bf16 v[160:163], a[64:67], a[16:19], v[160:163]
    ds_read_b64_tr_b16 a[62:63], v10 offset:10752
    v_mfma_f32_16x16x32_bf16 v[164:167], a[64:67], a[20:23], v[164:167]
    buffer_load_dwordx4 v6, s[8:11], s45 offen lds
    v_mfma_f32_16x16x32_bf16 v[168:171], a[64:67], a[24:27], v[168:171]
    s_add_u32 m0, s42, s54
    v_mfma_f32_16x16x32_bf16 v[172:175], a[64:67], a[28:31], v[172:175]
    ds_read_b64_tr_b16 a[64:65], v10 offset:7200
    v_mfma_f32_16x16x32_bf16 v[176:179], a[68:71], a[16:19], v[176:179]
    ds_read_b64_tr_b16 a[66:67], v10 offset:10784
    v_mfma_f32_16x16x32_bf16 v[180:183], a[68:71], a[20:23], v[180:183]
    buffer_load_dwordx4 v7, s[8:11], s45 offen lds
    v_mfma_f32_16x16x32_bf16 v[184:187], a[68:71], a[24:27], v[184:187]
    s_add_u32 m0, s42, s55
    v_mfma_f32_16x16x32_bf16 v[188:191], a[68:71], a[28:31], v[188:191]
    ds_read_b64_tr_b16 a[68:69], v10 offset:7232
    v_mfma_f32_16x16x32_bf16 v[192:195], a[72:75], a[16:19], v[192:195]
    ds_read_b64_tr_b16 a[70:71], v10 offset:10816
    v_mfma_f32_16x16x32_bf16 v[196:199], a[72:75], a[20:23], v[196:199]
    buffer_load_dwordx4 v8, s[8:11], s45 offen lds
    v_mfma_f32_16x16x32_bf16 v[200:203], a[72:75], a[24:27], v[200:203]
    s_add_u32 s43, s43, 1
    s_add_u32 s40, s40, 16384
    v_mfma_f32_16x16x32_bf16 v[204:207], a[72:75], a[28:31], v[204:207]
    ds_read_b64_tr_b16 a[72:73], v10 offset:7264
    v_mfma_f32_16x16x32_bf16 v[208:211], a[76:79], a[16:19], v[208:211]
    ds_read_b64_tr_b16 a[74:75], v10 offset:10848
    v_mfma_f32_16x16x32_bf16 v[212:215], a[76:79], a[20:23], v[212:215]
    s_add_u32 s41, s41, 229376
    s_add_u32 s42, s42, 30720
    v_mfma_f32_16x16x32_bf16 v[216:219], a[76:79], a[24:27], v[216:219]
    s_cmp_eq_u32 s42, 153600
    s_cselect_b32 s42, 0, s42
    v_mfma_f32_16x16x32_bf16 v[220:223], a[76:79], a[28:31], v[220:223]
    ds_read_b64_tr_b16 a[76:77], v10 offset:7296
    v_mfma_f32_16x16x32_bf16 v[224:227], a[80:83], a[16:19], v[224:227]
    ds_read_b64_tr_b16 a[78:79], v10 offset:10880
    v_mfma_f32_16x16x32_bf16 v[228:231], a[80:83], a[20:23], v[228:231]
    s_add_u32 s37, s46, 30720
    s_cmp_eq_u32 s37, 153600
    v_mfma_f32_16x16x32_bf16 v[232:235], a[80:83], a[24:27], v[232:235]
    s_cselect_b32 s37, 0, s37
    s_sub_u32 s38, s37, s46
    v_mfma_f32_16x16x32_bf16 v[236:239], a[80:83], a[28:31], v[236:239]
    ds_read_b64_tr_b16 a[80:81], v10 offset:7328
    v_mfma_f32_16x16x32_bf16 v[240:243], a[84:87], a[16:19], v[240:243]
    ds_read_b64_tr_b16 a[82:83], v10 offset:10912
    v_mfma_f32_16x16x32_bf16 v[244:247], a[84:87], a[20:23], v[244:247]
    s_mov_b32 s46, s37
    v_mfma_f32_16x16x32_bf16 v[248:251], a[84:87], a[24:27], v[248:251]
    s_waitcnt lgkmcnt(4)
    v_mfma_f32_16x16x32_bf16 v[252:255], a[84:87], a[28:31], v[252:255]
    ds_read_b64_tr_b16 a[84:85], v10 offset:7360
    ds_read_b64_tr_b16 a[86:87], v10 offset:10944
    s_sub_u32 s47, s47, 1
    s_cmp_lg_u32 s47, 0
    s_cbranch_scc1 MAIN_k3_gateup_kernel_2
    s_waitcnt lgkmcnt(0)
    s_getpc_b64 s[60:61]
PC_k3_gateup_kernel_3:
    s_add_u32 s60, s60, Lcode_k4_down_kernel-PC_k3_gateup_kernel_3
    s_addc_u32 s61, s61, 0
    s_lshr_b32 s62, s2, 3
    s_lshl_b32 s62, s62, 10
    s_min_u32 s62, s62, 3072
    v_and_b32 v3, 63, v0
    v_lshlrev_b32 v3, 4, v3
    v_add_u32 v3, s62, v3
    global_load_dwordx4 a[0:3], v3, s[60:61]
    v_and_b32 v3, 15, v2
    s_lshl_b32 s37, s33, 10
    v_lshl_add_u32 v3, v3, 4, s37
    v_add_u32 v3, 153600, v3
    v_lshrrev_b32 v4, 4, v2
    v_lshlrev_b32 v4, 4, v4
    v_add_u32 v4, 157696, v4
    v_lshlrev_b32 v1, 4, v2
    s_lshl_b32 s37, s34, 3
    s_lshl_b32 s38, s33, 1
    s_add_u32 s37, s37, s38
    s_mul_i32 s50, s37, 224
    s_mul_i32 s51, s35, 7
    s_add_u32 s50, s50, s51
    s_lshl_b32 s50, s50, 10
    ds_read_b128 v[8:11], v3 offset:0
    ds_read_b128 v[12:15], v3 offset:256
    ds_read_b128 v[24:27], v4 offset:0
    ds_read_b128 v[28:31], v4 offset:448
    s_add_u32 s38, s50, 0
    s_waitcnt lgkmcnt(0)
    v_pk_fma_f32 v[32:33], v[24:25], v[8:9], v[32:33] op_sel_hi:[1,0,1]
    v_pk_fma_f32 v[34:35], v[26:27], v[8:9], v[34:35] op_sel_hi:[1,0,1]
    v_pk_fma_f32 v[36:37], v[24:25], v[12:13], v[36:37] op_sel_hi:[1,0,1]
    v_pk_fma_f32 v[38:39], v[26:27], v[12:13], v[38:39] op_sel_hi:[1,0,1]
    ds_read_b128 v[24:27], v4 offset:64
    v_pk_mul_f32 v[16:17], v[32:33], v[32:33]
    v_pk_mul_f32 v[18:19], v[34:35], v[34:35]
    v_pk_mul_f32 v[20:21], v[36:37], v[36:37]
    v_pk_mul_f32 v[22:23], v[38:39], v[38:39]
    v_pk_fma_f32 v[16:17], v[16:17], v[10:11], v[8:9] op_sel:[0,0,1] op_sel_hi:[1,0,1]
    v_pk_fma_f32 v[18:19], v[18:19], v[10:11], v[8:9] op_sel:[0,0,1] op_sel_hi:[1,0,1]
    v_pk_fma_f32 v[20:21], v[20:21], v[14:15], v[12:13] op_sel:[0,0,1] op_sel_hi:[1,0,1]
    v_pk_fma_f32 v[22:23], v[22:23], v[14:15], v[12:13] op_sel:[0,0,1] op_sel_hi:[1,0,1]
    v_pk_mul_f32 v[16:17], v[16:17], v[32:33]
    v_pk_mul_f32 v[18:19], v[18:19], v[34:35]
    v_pk_mul_f32 v[20:21], v[20:21], v[36:37]
    v_pk_mul_f32 v[22:23], v[22:23], v[38:39]
    v_exp_f32 v16, v16
    v_exp_f32 v17, v17
    v_exp_f32 v18, v18
    v_exp_f32 v19, v19
    v_exp_f32 v20, v20
    v_exp_f32 v21, v21
    v_exp_f32 v22, v22
    v_exp_f32 v23, v23
    s_waitcnt lgkmcnt(1)
    v_pk_fma_f32 v[144:145], v[28:29], v[8:9], v[144:145] op_sel_hi:[1,0,1]
    v_pk_fma_f32 v[146:147], v[30:31], v[8:9], v[146:147] op_sel_hi:[1,0,1]
    v_pk_fma_f32 v[148:149], v[28:29], v[12:13], v[148:149] op_sel_hi:[1,0,1]
    v_pk_fma_f32 v[150:151], v[30:31], v[12:13], v[150:151] op_sel_hi:[1,0,1]
    ds_read_b128 v[28:31], v4 offset:512
    v_pk_fma_f32 v[16:17], v[16:17], v[10:11], v[10:11] op_sel:[0,1,1] op_sel_hi:[1,1,1]
    v_pk_fma_f32 v[18:19], v[18:19], v[10:11], v[10:11] op_sel:[0,1,1] op_sel_hi:[1,1,1]
    v_pk_fma_f32 v[20:21], v[20:21], v[14:15], v[14:15] op_sel:[0,1,1] op_sel_hi:[1,1,1]
    v_pk_fma_f32 v[22:23], v[22:23], v[14:15], v[14:15] op_sel:[0,1,1] op_sel_hi:[1,1,1]
    v_rcp_f32 v16, v16
    v_rcp_f32 v17, v17
    v_rcp_f32 v18, v18
    v_rcp_f32 v19, v19
    v_rcp_f32 v20, v20
    v_rcp_f32 v21, v21
    v_rcp_f32 v22, v22
    v_rcp_f32 v23, v23
    v_pk_mul_f32 v[144:145], v[144:145], v[32:33]
    v_pk_mul_f32 v[146:147], v[146:147], v[34:35]
    v_pk_mul_f32 v[148:149], v[148:149], v[36:37]
    v_pk_mul_f32 v[150:151], v[150:151], v[38:39]
    v_pk_mul_f32 v[144:145], v[144:145], v[16:17]
    v_pk_mul_f32 v[146:147], v[146:147], v[18:19]
    v_pk_mul_f32 v[148:149], v[148:149], v[20:21]
    v_pk_mul_f32 v[150:151], v[150:151], v[22:23]
    v_cvt_pk_bf16_f32 v32, v144, v145
    v_cvt_pk_bf16_f32 v33, v146, v147
    v_cvt_pk_bf16_f32 v34, v148, v149
    v_cvt_pk_bf16_f32 v35, v150, v151
    s_nop 1
    v_permlane16_swap_b32 v32, v34
    v_permlane16_swap_b32 v33, v35
    buffer_store_dwordx4 v[32:35], v1, s[20:23], s38 offen sc1
    s_add_u32 s38, s50, 1024
    s_waitcnt lgkmcnt(1)
    v_pk_fma_f32 v[48:49], v[24:25], v[8:9], v[48:49] op_sel_hi:[1,0,1]
    v_pk_fma_f32 v[50:51], v[26:27], v[8:9], v[50:51] op_sel_hi:[1,0,1]
    v_pk_fma_f32 v[52:53], v[24:25], v[12:13], v[52:53] op_sel_hi:[1,0,1]
    v_pk_fma_f32 v[54:55], v[26:27], v[12:13], v[54:55] op_sel_hi:[1,0,1]
    ds_read_b128 v[24:27], v4 offset:128
    v_pk_mul_f32 v[16:17], v[48:49], v[48:49]
    v_pk_mul_f32 v[18:19], v[50:51], v[50:51]
    v_pk_mul_f32 v[20:21], v[52:53], v[52:53]
    v_pk_mul_f32 v[22:23], v[54:55], v[54:55]
    v_pk_fma_f32 v[16:17], v[16:17], v[10:11], v[8:9] op_sel:[0,0,1] op_sel_hi:[1,0,1]
    v_pk_fma_f32 v[18:19], v[18:19], v[10:11], v[8:9] op_sel:[0,0,1] op_sel_hi:[1,0,1]
    v_pk_fma_f32 v[20:21], v[20:21], v[14:15], v[12:13] op_sel:[0,0,1] op_sel_hi:[1,0,1]
    v_pk_fma_f32 v[22:23], v[22:23], v[14:15], v[12:13] op_sel:[0,0,1] op_sel_hi:[1,0,1]
    v_pk_mul_f32 v[16:17], v[16:17], v[48:49]
    v_pk_mul_f32 v[18:19], v[18:19], v[50:51]
    v_pk_mul_f32 v[20:21], v[20:21], v[52:53]
    v_pk_mul_f32 v[22:23], v[22:23], v[54:55]
    v_exp_f32 v16, v16
    v_exp_f32 v17, v17
    v_exp_f32 v18, v18
    v_exp_f32 v19, v19
    v_exp_f32 v20, v20
    v_exp_f32 v21, v21
    v_exp_f32 v22, v22
    v_exp_f32 v23, v23
    s_waitcnt lgkmcnt(1)
    v_pk_fma_f32 v[160:161], v[28:29], v[8:9], v[160:161] op_sel_hi:[1,0,1]
    v_pk_fma_f32 v[162:163], v[30:31], v[8:9], v[162:163] op_sel_hi:[1,0,1]
    v_pk_fma_f32 v[164:165], v[28:29], v[12:13], v[164:165] op_sel_hi:[1,0,1]
    v_pk_fma_f32 v[166:167], v[30:31], v[12:13], v[166:167] op_sel_hi:[1,0,1]
    ds_read_b128 v[28:31], v4 offset:576
    v_pk_fma_f32 v[16:17], v[16:17], v[10:11], v[10:11] op_sel:[0,1,1] op_sel_hi:[1,1,1]
    v_pk_fma_f32 v[18:19], v[18:19], v[10:11], v[10:11] op_sel:[0,1,1] op_sel_hi:[1,1,1]
    v_pk_fma_f32 v[20:21], v[20:21], v[14:15], v[14:15] op_sel:[0,1,1] op_sel_hi:[1,1,1]
    v_pk_fma_f32 v[22:23], v[22:23], v[14:15], v[14:15] op_sel:[0,1,1] op_sel_hi:[1,1,1]
    v_rcp_f32 v16, v16
    v_rcp_f32 v17, v17
    v_rcp_f32 v18, v18
    v_rcp_f32 v19, v19
    v_rcp_f32 v20, v20
    v_rcp_f32 v21, v21
    v_rcp_f32 v22, v22
    v_rcp_f32 v23, v23
    v_pk_mul_f32 v[160:161], v[160:161], v[48:49]
    v_pk_mul_f32 v[162:163], v[162:163], v[50:51]
    v_pk_mul_f32 v[164:165], v[164:165], v[52:53]
    v_pk_mul_f32 v[166:167], v[166:167], v[54:55]
    v_pk_mul_f32 v[160:161], v[160:161], v[16:17]
    v_pk_mul_f32 v[162:163], v[162:163], v[18:19]
    v_pk_mul_f32 v[164:165], v[164:165], v[20:21]
    v_pk_mul_f32 v[166:167], v[166:167], v[22:23]
    v_cvt_pk_bf16_f32 v48, v160, v161
    v_cvt_pk_bf16_f32 v49, v162, v163
    v_cvt_pk_bf16_f32 v50, v164, v165
    v_cvt_pk_bf16_f32 v51, v166, v167
    s_nop 1
    v_permlane16_swap_b32 v48, v50
    v_permlane16_swap_b32 v49, v51
    buffer_store_dwordx4 v[48:51], v1, s[20:23], s38 offen sc1
    s_add_u32 s38, s50, 2048
    s_waitcnt lgkmcnt(1)
    v_pk_fma_f32 v[64:65], v[24:25], v[8:9], v[64:65] op_sel_hi:[1,0,1]
    v_pk_fma_f32 v[66:67], v[26:27], v[8:9], v[66:67] op_sel_hi:[1,0,1]
    v_pk_fma_f32 v[68:69], v[24:25], v[12:13], v[68:69] op_sel_hi:[1,0,1]
    v_pk_fma_f32 v[70:71], v[26:27], v[12:13], v[70:71] op_sel_hi:[1,0,1]
    ds_read_b128 v[24:27], v4 offset:192
    v_pk_mul_f32 v[16:17], v[64:65], v[64:65]
    v_pk_mul_f32 v[18:19], v[66:67], v[66:67]
    v_pk_mul_f32 v[20:21], v[68:69], v[68:69]
    v_pk_mul_f32 v[22:23], v[70:71], v[70:71]
    v_pk_fma_f32 v[16:17], v[16:17], v[10:11], v[8:9] op_sel:[0,0,1] op_sel_hi:[1,0,1]
    v_pk_fma_f32 v[18:19], v[18:19], v[10:11], v[8:9] op_sel:[0,0,1] op_sel_hi:[1,0,1]
    v_pk_fma_f32 v[20:21], v[20:21], v[14:15], v[12:13] op_sel:[0,0,1] op_sel_hi:[1,0,1]
    v_pk_fma_f32 v[22:23], v[22:23], v[14:15], v[12:13] op_sel:[0,0,1] op_sel_hi:[1,0,1]
    v_pk_mul_f32 v[16:17], v[16:17], v[64:65]
    v_pk_mul_f32 v[18:19], v[18:19], v[66:67]
    v_pk_mul_f32 v[20:21], v[20:21], v[68:69]
    v_pk_mul_f32 v[22:23], v[22:23], v[70:71]
    v_exp_f32 v16, v16
    v_exp_f32 v17, v17
    v_exp_f32 v18, v18
    v_exp_f32 v19, v19
    v_exp_f32 v20, v20
    v_exp_f32 v21, v21
    v_exp_f32 v22, v22
    v_exp_f32 v23, v23
    s_waitcnt lgkmcnt(1)
    v_pk_fma_f32 v[176:177], v[28:29], v[8:9], v[176:177] op_sel_hi:[1,0,1]
    v_pk_fma_f32 v[178:179], v[30:31], v[8:9], v[178:179] op_sel_hi:[1,0,1]
    v_pk_fma_f32 v[180:181], v[28:29], v[12:13], v[180:181] op_sel_hi:[1,0,1]
    v_pk_fma_f32 v[182:183], v[30:31], v[12:13], v[182:183] op_sel_hi:[1,0,1]
    ds_read_b128 v[28:31], v4 offset:640
    v_pk_fma_f32 v[16:17], v[16:17], v[10:11], v[10:11] op_sel:[0,1,1] op_sel_hi:[1,1,1]
    v_pk_fma_f32 v[18:19], v[18:19], v[10:11], v[10:11] op_sel:[0,1,1] op_sel_hi:[1,1,1]
    v_pk_fma_f32 v[20:21], v[20:21], v[14:15], v[14:15] op_sel:[0,1,1] op_sel_hi:[1,1,1]
    v_pk_fma_f32 v[22:23], v[22:23], v[14:15], v[14:15] op_sel:[0,1,1] op_sel_hi:[1,1,1]
    v_rcp_f32 v16, v16
    v_rcp_f32 v17, v17
    v_rcp_f32 v18, v18
    v_rcp_f32 v19, v19
    v_rcp_f32 v20, v20
    v_rcp_f32 v21, v21
    v_rcp_f32 v22, v22
    v_rcp_f32 v23, v23
    v_pk_mul_f32 v[176:177], v[176:177], v[64:65]
    v_pk_mul_f32 v[178:179], v[178:179], v[66:67]
    v_pk_mul_f32 v[180:181], v[180:181], v[68:69]
    v_pk_mul_f32 v[182:183], v[182:183], v[70:71]
    v_pk_mul_f32 v[176:177], v[176:177], v[16:17]
    v_pk_mul_f32 v[178:179], v[178:179], v[18:19]
    v_pk_mul_f32 v[180:181], v[180:181], v[20:21]
    v_pk_mul_f32 v[182:183], v[182:183], v[22:23]
    v_cvt_pk_bf16_f32 v64, v176, v177
    v_cvt_pk_bf16_f32 v65, v178, v179
    v_cvt_pk_bf16_f32 v66, v180, v181
    v_cvt_pk_bf16_f32 v67, v182, v183
    s_nop 1
    v_permlane16_swap_b32 v64, v66
    v_permlane16_swap_b32 v65, v67
    buffer_store_dwordx4 v[64:67], v1, s[20:23], s38 offen sc1
    s_add_u32 s38, s50, 3072
    s_waitcnt lgkmcnt(1)
    v_pk_fma_f32 v[80:81], v[24:25], v[8:9], v[80:81] op_sel_hi:[1,0,1]
    v_pk_fma_f32 v[82:83], v[26:27], v[8:9], v[82:83] op_sel_hi:[1,0,1]
    v_pk_fma_f32 v[84:85], v[24:25], v[12:13], v[84:85] op_sel_hi:[1,0,1]
    v_pk_fma_f32 v[86:87], v[26:27], v[12:13], v[86:87] op_sel_hi:[1,0,1]
    ds_read_b128 v[24:27], v4 offset:256
    v_pk_mul_f32 v[16:17], v[80:81], v[80:81]
    v_pk_mul_f32 v[18:19], v[82:83], v[82:83]
    v_pk_mul_f32 v[20:21], v[84:85], v[84:85]
    v_pk_mul_f32 v[22:23], v[86:87], v[86:87]
    v_pk_fma_f32 v[16:17], v[16:17], v[10:11], v[8:9] op_sel:[0,0,1] op_sel_hi:[1,0,1]
    v_pk_fma_f32 v[18:19], v[18:19], v[10:11], v[8:9] op_sel:[0,0,1] op_sel_hi:[1,0,1]
    v_pk_fma_f32 v[20:21], v[20:21], v[14:15], v[12:13] op_sel:[0,0,1] op_sel_hi:[1,0,1]
    v_pk_fma_f32 v[22:23], v[22:23], v[14:15], v[12:13] op_sel:[0,0,1] op_sel_hi:[1,0,1]
    v_pk_mul_f32 v[16:17], v[16:17], v[80:81]
    v_pk_mul_f32 v[18:19], v[18:19], v[82:83]
    v_pk_mul_f32 v[20:21], v[20:21], v[84:85]
    v_pk_mul_f32 v[22:23], v[22:23], v[86:87]
    v_exp_f32 v16, v16
    v_exp_f32 v17, v17
    v_exp_f32 v18, v18
    v_exp_f32 v19, v19
    v_exp_f32 v20, v20
    v_exp_f32 v21, v21
    v_exp_f32 v22, v22
    v_exp_f32 v23, v23
    s_waitcnt lgkmcnt(1)
    v_pk_fma_f32 v[192:193], v[28:29], v[8:9], v[192:193] op_sel_hi:[1,0,1]
    v_pk_fma_f32 v[194:195], v[30:31], v[8:9], v[194:195] op_sel_hi:[1,0,1]
    v_pk_fma_f32 v[196:197], v[28:29], v[12:13], v[196:197] op_sel_hi:[1,0,1]
    v_pk_fma_f32 v[198:199], v[30:31], v[12:13], v[198:199] op_sel_hi:[1,0,1]
    ds_read_b128 v[28:31], v4 offset:704
    v_pk_fma_f32 v[16:17], v[16:17], v[10:11], v[10:11] op_sel:[0,1,1] op_sel_hi:[1,1,1]
    v_pk_fma_f32 v[18:19], v[18:19], v[10:11], v[10:11] op_sel:[0,1,1] op_sel_hi:[1,1,1]
    v_pk_fma_f32 v[20:21], v[20:21], v[14:15], v[14:15] op_sel:[0,1,1] op_sel_hi:[1,1,1]
    v_pk_fma_f32 v[22:23], v[22:23], v[14:15], v[14:15] op_sel:[0,1,1] op_sel_hi:[1,1,1]
    v_rcp_f32 v16, v16
    v_rcp_f32 v17, v17
    v_rcp_f32 v18, v18
    v_rcp_f32 v19, v19
    v_rcp_f32 v20, v20
    v_rcp_f32 v21, v21
    v_rcp_f32 v22, v22
    v_rcp_f32 v23, v23
    v_pk_mul_f32 v[192:193], v[192:193], v[80:81]
    v_pk_mul_f32 v[194:195], v[194:195], v[82:83]
    v_pk_mul_f32 v[196:197], v[196:197], v[84:85]
    v_pk_mul_f32 v[198:199], v[198:199], v[86:87]
    v_pk_mul_f32 v[192:193], v[192:193], v[16:17]
    v_pk_mul_f32 v[194:195], v[194:195], v[18:19]
    v_pk_mul_f32 v[196:197], v[196:197], v[20:21]
    v_pk_mul_f32 v[198:199], v[198:199], v[22:23]
    v_cvt_pk_bf16_f32 v80, v192, v193
    v_cvt_pk_bf16_f32 v81, v194, v195
    v_cvt_pk_bf16_f32 v82, v196, v197
    v_cvt_pk_bf16_f32 v83, v198, v199
    s_nop 1
    v_permlane16_swap_b32 v80, v82
    v_permlane16_swap_b32 v81, v83
    buffer_store_dwordx4 v[80:83], v1, s[20:23], s38 offen sc1
    s_add_u32 s38, s50, 4096
    s_waitcnt lgkmcnt(1)
    v_pk_fma_f32 v[96:97], v[24:25], v[8:9], v[96:97] op_sel_hi:[1,0,1]
    v_pk_fma_f32 v[98:99], v[26:27], v[8:9], v[98:99] op_sel_hi:[1,0,1]
    v_pk_fma_f32 v[100:101], v[24:25], v[12:13], v[100:101] op_sel_hi:[1,0,1]
    v_pk_fma_f32 v[102:103], v[26:27], v[12:13], v[102:103] op_sel_hi:[1,0,1]
    ds_read_b128 v[24:27], v4 offset:320
    v_pk_mul_f32 v[16:17], v[96:97], v[96:97]
    v_pk_mul_f32 v[18:19], v[98:99], v[98:99]
    v_pk_mul_f32 v[20:21], v[100:101], v[100:101]
    v_pk_mul_f32 v[22:23], v[102:103], v[102:103]
    v_pk_fma_f32 v[16:17], v[16:17], v[10:11], v[8:9] op_sel:[0,0,1] op_sel_hi:[1,0,1]
    v_pk_fma_f32 v[18:19], v[18:19], v[10:11], v[8:9] op_sel:[0,0,1] op_sel_hi:[1,0,1]
    v_pk_fma_f32 v[20:21], v[20:21], v[14:15], v[12:13] op_sel:[0,0,1] op_sel_hi:[1,0,1]
    v_pk_fma_f32 v[22:23], v[22:23], v[14:15], v[12:13] op_sel:[0,0,1] op_sel_hi:[1,0,1]
    v_pk_mul_f32 v[16:17], v[16:17], v[96:97]
    v_pk_mul_f32 v[18:19], v[18:19], v[98:99]
    v_pk_mul_f32 v[20:21], v[20:21], v[100:101]
    v_pk_mul_f32 v[22:23], v[22:23], v[102:103]
    v_exp_f32 v16, v16
    v_exp_f32 v17, v17
    v_exp_f32 v18, v18
    v_exp_f32 v19, v19
    v_exp_f32 v20, v20
    v_exp_f32 v21, v21
    v_exp_f32 v22, v22
    v_exp_f32 v23, v23
    s_waitcnt lgkmcnt(1)
    v_pk_fma_f32 v[208:209], v[28:29], v[8:9], v[208:209] op_sel_hi:[1,0,1]
    v_pk_fma_f32 v[210:211], v[30:31], v[8:9], v[210:211] op_sel_hi:[1,0,1]
    v_pk_fma_f32 v[212:213], v[28:29], v[12:13], v[212:213] op_sel_hi:[1,0,1]
    v_pk_fma_f32 v[214:215], v[30:31], v[12:13], v[214:215] op_sel_hi:[1,0,1]
    ds_read_b128 v[28:31], v4 offset:768
    v_pk_fma_f32 v[16:17], v[16:17], v[10:11], v[10:11] op_sel:[0,1,1] op_sel_hi:[1,1,1]
    v_pk_fma_f32 v[18:19], v[18:19], v[10:11], v[10:11] op_sel:[0,1,1] op_sel_hi:[1,1,1]
    v_pk_fma_f32 v[20:21], v[20:21], v[14:15], v[14:15] op_sel:[0,1,1] op_sel_hi:[1,1,1]
    v_pk_fma_f32 v[22:23], v[22:23], v[14:15], v[14:15] op_sel:[0,1,1] op_sel_hi:[1,1,1]
    v_rcp_f32 v16, v16
    v_rcp_f32 v17, v17
    v_rcp_f32 v18, v18
    v_rcp_f32 v19, v19
    v_rcp_f32 v20, v20
    v_rcp_f32 v21, v21
    v_rcp_f32 v22, v22
    v_rcp_f32 v23, v23
    v_pk_mul_f32 v[208:209], v[208:209], v[96:97]
    v_pk_mul_f32 v[210:211], v[210:211], v[98:99]
    v_pk_mul_f32 v[212:213], v[212:213], v[100:101]
    v_pk_mul_f32 v[214:215], v[214:215], v[102:103]
    v_pk_mul_f32 v[208:209], v[208:209], v[16:17]
    v_pk_mul_f32 v[210:211], v[210:211], v[18:19]
    v_pk_mul_f32 v[212:213], v[212:213], v[20:21]
    v_pk_mul_f32 v[214:215], v[214:215], v[22:23]
    v_cvt_pk_bf16_f32 v96, v208, v209
    v_cvt_pk_bf16_f32 v97, v210, v211
    v_cvt_pk_bf16_f32 v98, v212, v213
    v_cvt_pk_bf16_f32 v99, v214, v215
    s_nop 1
    v_permlane16_swap_b32 v96, v98
    v_permlane16_swap_b32 v97, v99
    buffer_store_dwordx4 v[96:99], v1, s[20:23], s38 offen sc1
    s_add_u32 s38, s50, 5120
    s_waitcnt lgkmcnt(1)
    v_pk_fma_f32 v[112:113], v[24:25], v[8:9], v[112:113] op_sel_hi:[1,0,1]
    v_pk_fma_f32 v[114:115], v[26:27], v[8:9], v[114:115] op_sel_hi:[1,0,1]
    v_pk_fma_f32 v[116:117], v[24:25], v[12:13], v[116:117] op_sel_hi:[1,0,1]
    v_pk_fma_f32 v[118:119], v[26:27], v[12:13], v[118:119] op_sel_hi:[1,0,1]
    ds_read_b128 v[24:27], v4 offset:384
    v_pk_mul_f32 v[16:17], v[112:113], v[112:113]
    v_pk_mul_f32 v[18:19], v[114:115], v[114:115]
    v_pk_mul_f32 v[20:21], v[116:117], v[116:117]
    v_pk_mul_f32 v[22:23], v[118:119], v[118:119]
    v_pk_fma_f32 v[16:17], v[16:17], v[10:11], v[8:9] op_sel:[0,0,1] op_sel_hi:[1,0,1]
    v_pk_fma_f32 v[18:19], v[18:19], v[10:11], v[8:9] op_sel:[0,0,1] op_sel_hi:[1,0,1]
    v_pk_fma_f32 v[20:21], v[20:21], v[14:15], v[12:13] op_sel:[0,0,1] op_sel_hi:[1,0,1]
    v_pk_fma_f32 v[22:23], v[22:23], v[14:15], v[12:13] op_sel:[0,0,1] op_sel_hi:[1,0,1]
    v_pk_mul_f32 v[16:17], v[16:17], v[112:113]
    v_pk_mul_f32 v[18:19], v[18:19], v[114:115]
    v_pk_mul_f32 v[20:21], v[20:21], v[116:117]
    v_pk_mul_f32 v[22:23], v[22:23], v[118:119]
    v_exp_f32 v16, v16
    v_exp_f32 v17, v17
    v_exp_f32 v18, v18
    v_exp_f32 v19, v19
    v_exp_f32 v20, v20
    v_exp_f32 v21, v21
    v_exp_f32 v22, v22
    v_exp_f32 v23, v23
    s_waitcnt lgkmcnt(1)
    v_pk_fma_f32 v[224:225], v[28:29], v[8:9], v[224:225] op_sel_hi:[1,0,1]
    v_pk_fma_f32 v[226:227], v[30:31], v[8:9], v[226:227] op_sel_hi:[1,0,1]
    v_pk_fma_f32 v[228:229], v[28:29], v[12:13], v[228:229] op_sel_hi:[1,0,1]
    v_pk_fma_f32 v[230:231], v[30:31], v[12:13], v[230:231] op_sel_hi:[1,0,1]
    ds_read_b128 v[28:31], v4 offset:832
    v_pk_fma_f32 v[16:17], v[16:17], v[10:11], v[10:11] op_sel:[0,1,1] op_sel_hi:[1,1,1]
    v_pk_fma_f32 v[18:19], v[18:19], v[10:11], v[10:11] op_sel:[0,1,1] op_sel_hi:[1,1,1]
    v_pk_fma_f32 v[20:21], v[20:21], v[14:15], v[14:15] op_sel:[0,1,1] op_sel_hi:[1,1,1]
    v_pk_fma_f32 v[22:23], v[22:23], v[14:15], v[14:15] op_sel:[0,1,1] op_sel_hi:[1,1,1]
    v_rcp_f32 v16, v16
    v_rcp_f32 v17, v17
    v_rcp_f32 v18, v18
    v_rcp_f32 v19, v19
    v_rcp_f32 v20, v20
    v_rcp_f32 v21, v21
    v_rcp_f32 v22, v22
    v_rcp_f32 v23, v23
    v_pk_mul_f32 v[224:225], v[224:225], v[112:113]
    v_pk_mul_f32 v[226:227], v[226:227], v[114:115]
    v_pk_mul_f32 v[228:229], v[228:229], v[116:117]
    v_pk_mul_f32 v[230:231], v[230:231], v[118:119]
    v_pk_mul_f32 v[224:225], v[224:225], v[16:17]
    v_pk_mul_f32 v[226:227], v[226:227], v[18:19]
    v_pk_mul_f32 v[228:229], v[228:229], v[20:21]
    v_pk_mul_f32 v[230:231], v[230:231], v[22:23]
    v_cvt_pk_bf16_f32 v112, v224, v225
    v_cvt_pk_bf16_f32 v113, v226, v227
    v_cvt_pk_bf16_f32 v114, v228, v229
    v_cvt_pk_bf16_f32 v115, v230, v231
    s_nop 1
    v_permlane16_swap_b32 v112, v114
    v_permlane16_swap_b32 v113, v115
    buffer_store_dwordx4 v[112:115], v1, s[20:23], s38 offen sc1
    s_add_u32 s38, s50, 6144
    s_waitcnt lgkmcnt(1)
    v_pk_fma_f32 v[128:129], v[24:25], v[8:9], v[128:129] op_sel_hi:[1,0,1]
    v_pk_fma_f32 v[130:131], v[26:27], v[8:9], v[130:131] op_sel_hi:[1,0,1]
    v_pk_fma_f32 v[132:133], v[24:25], v[12:13], v[132:133] op_sel_hi:[1,0,1]
    v_pk_fma_f32 v[134:135], v[26:27], v[12:13], v[134:135] op_sel_hi:[1,0,1]
    ds_read_b128 v[24:27], v4 offset:0
    v_pk_mul_f32 v[16:17], v[128:129], v[128:129]
    v_pk_mul_f32 v[18:19], v[130:131], v[130:131]
    v_pk_mul_f32 v[20:21], v[132:133], v[132:133]
    v_pk_mul_f32 v[22:23], v[134:135], v[134:135]
    v_pk_fma_f32 v[16:17], v[16:17], v[10:11], v[8:9] op_sel:[0,0,1] op_sel_hi:[1,0,1]
    v_pk_fma_f32 v[18:19], v[18:19], v[10:11], v[8:9] op_sel:[0,0,1] op_sel_hi:[1,0,1]
    v_pk_fma_f32 v[20:21], v[20:21], v[14:15], v[12:13] op_sel:[0,0,1] op_sel_hi:[1,0,1]
    v_pk_fma_f32 v[22:23], v[22:23], v[14:15], v[12:13] op_sel:[0,0,1] op_sel_hi:[1,0,1]
    v_pk_mul_f32 v[16:17], v[16:17], v[128:129]
    v_pk_mul_f32 v[18:19], v[18:19], v[130:131]
    v_pk_mul_f32 v[20:21], v[20:21], v[132:133]
    v_pk_mul_f32 v[22:23], v[22:23], v[134:135]
    v_exp_f32 v16, v16
    v_exp_f32 v17, v17
    v_exp_f32 v18, v18
    v_exp_f32 v19, v19
    v_exp_f32 v20, v20
    v_exp_f32 v21, v21
    v_exp_f32 v22, v22
    v_exp_f32 v23, v23
    s_waitcnt lgkmcnt(1)
    v_pk_fma_f32 v[240:241], v[28:29], v[8:9], v[240:241] op_sel_hi:[1,0,1]
    v_pk_fma_f32 v[242:243], v[30:31], v[8:9], v[242:243] op_sel_hi:[1,0,1]
    v_pk_fma_f32 v[244:245], v[28:29], v[12:13], v[244:245] op_sel_hi:[1,0,1]
    v_pk_fma_f32 v[246:247], v[30:31], v[12:13], v[246:247] op_sel_hi:[1,0,1]
    ds_read_b128 v[28:31], v4 offset:448
    v_pk_fma_f32 v[16:17], v[16:17], v[10:11], v[10:11] op_sel:[0,1,1] op_sel_hi:[1,1,1]
    v_pk_fma_f32 v[18:19], v[18:19], v[10:11], v[10:11] op_sel:[0,1,1] op_sel_hi:[1,1,1]
    v_pk_fma_f32 v[20:21], v[20:21], v[14:15], v[14:15] op_sel:[0,1,1] op_sel_hi:[1,1,1]
    v_pk_fma_f32 v[22:23], v[22:23], v[14:15], v[14:15] op_sel:[0,1,1] op_sel_hi:[1,1,1]
    v_rcp_f32 v16, v16
    v_rcp_f32 v17, v17
    v_rcp_f32 v18, v18
    v_rcp_f32 v19, v19
    v_rcp_f32 v20, v20
    v_rcp_f32 v21, v21
    v_rcp_f32 v22, v22
    v_rcp_f32 v23, v23
    v_pk_mul_f32 v[240:241], v[240:241], v[128:129]
    v_pk_mul_f32 v[242:243], v[242:243], v[130:131]
    v_pk_mul_f32 v[244:245], v[244:245], v[132:133]
    v_pk_mul_f32 v[246:247], v[246:247], v[134:135]
    v_pk_mul_f32 v[240:241], v[240:241], v[16:17]
    v_pk_mul_f32 v[242:243], v[242:243], v[18:19]
    v_pk_mul_f32 v[244:245], v[244:245], v[20:21]
    v_pk_mul_f32 v[246:247], v[246:247], v[22:23]
    v_cvt_pk_bf16_f32 v128, v240, v241
    v_cvt_pk_bf16_f32 v129, v242, v243
    v_cvt_pk_bf16_f32 v130, v244, v245
    v_cvt_pk_bf16_f32 v131, v246, v247
    s_nop 1
    v_permlane16_swap_b32 v128, v130
    v_permlane16_swap_b32 v129, v131
    buffer_store_dwordx4 v[128:131], v1, s[20:23], s38 offen sc1
    ds_read_b128 v[8:11], v3 offset:512
    ds_read_b128 v[12:15], v3 offset:768
    s_add_u32 s38, s50, 229376
    s_waitcnt lgkmcnt(0)
    v_pk_fma_f32 v[40:41], v[24:25], v[8:9], v[40:41] op_sel_hi:[1,0,1]
    v_pk_fma_f32 v[42:43], v[26:27], v[8:9], v[42:43] op_sel_hi:[1,0,1]
    v_pk_fma_f32 v[44:45], v[24:25], v[12:13], v[44:45] op_sel_hi:[1,0,1]
    v_pk_fma_f32 v[46:47], v[26:27], v[12:13], v[46:47] op_sel_hi:[1,0,1]
    ds_read_b128 v[24:27], v4 offset:64
    v_pk_mul_f32 v[16:17], v[40:41], v[40:41]
    v_pk_mul_f32 v[18:19], v[42:43], v[42:43]
    v_pk_mul_f32 v[20:21], v[44:45], v[44:45]
    v_pk_mul_f32 v[22:23], v[46:47], v[46:47]
    v_pk_fma_f32 v[16:17], v[16:17], v[10:11], v[8:9] op_sel:[0,0,1] op_sel_hi:[1,0,1]
    v_pk_fma_f32 v[18:19], v[18:19], v[10:11], v[8:9] op_sel:[0,0,1] op_sel_hi:[1,0,1]
    v_pk_fma_f32 v[20:21], v[20:21], v[14:15], v[12:13] op_sel:[0,0,1] op_sel_hi:[1,0,1]
    v_pk_fma_f32 v[22:23], v[22:23], v[14:15], v[12:13] op_sel:[0,0,1] op_sel_hi:[1,0,1]
    v_pk_mul_f32 v[16:17], v[16:17], v[40:41]
    v_pk_mul_f32 v[18:19], v[18:19], v[42:43]
    v_pk_mul_f32 v[20:21], v[20:21], v[44:45]
    v_pk_mul_f32 v[22:23], v[22:23], v[46:47]
    v_exp_f32 v16, v16
    v_exp_f32 v17, v17
    v_exp_f32 v18, v18
    v_exp_f32 v19, v19
    v_exp_f32 v20, v20
    v_exp_f32 v21, v21
    v_exp_f32 v22, v22
    v_exp_f32 v23, v23
    s_waitcnt lgkmcnt(1)
    v_pk_fma_f32 v[152:153], v[28:29], v[8:9], v[152:153] op_sel_hi:[1,0,1]
    v_pk_fma_f32 v[154:155], v[30:31], v[8:9], v[154:155] op_sel_hi:[1,0,1]
    v_pk_fma_f32 v[156:157], v[28:29], v[12:13], v[156:157] op_sel_hi:[1,0,1]
    v_pk_fma_f32 v[158:159], v[30:31], v[12:13], v[158:159] op_sel_hi:[1,0,1]
    ds_read_b128 v[28:31], v4 offset:512
    v_pk_fma_f32 v[16:17], v[16:17], v[10:11], v[10:11] op_sel:[0,1,1] op_sel_hi:[1,1,1]
    v_pk_fma_f32 v[18:19], v[18:19], v[10:11], v[10:11] op_sel:[0,1,1] op_sel_hi:[1,1,1]
    v_pk_fma_f32 v[20:21], v[20:21], v[14:15], v[14:15] op_sel:[0,1,1] op_sel_hi:[1,1,1]
    v_pk_fma_f32 v[22:23], v[22:23], v[14:15], v[14:15] op_sel:[0,1,1] op_sel_hi:[1,1,1]
    v_rcp_f32 v16, v16
    v_rcp_f32 v17, v17
    v_rcp_f32 v18, v18
    v_rcp_f32 v19, v19
    v_rcp_f32 v20, v20
    v_rcp_f32 v21, v21
    v_rcp_f32 v22, v22
    v_rcp_f32 v23, v23
    v_pk_mul_f32 v[152:153], v[152:153], v[40:41]
    v_pk_mul_f32 v[154:155], v[154:155], v[42:43]
    v_pk_mul_f32 v[156:157], v[156:157], v[44:45]
    v_pk_mul_f32 v[158:159], v[158:159], v[46:47]
    v_pk_mul_f32 v[152:153], v[152:153], v[16:17]
    v_pk_mul_f32 v[154:155], v[154:155], v[18:19]
    v_pk_mul_f32 v[156:157], v[156:157], v[20:21]
    v_pk_mul_f32 v[158:159], v[158:159], v[22:23]
    v_cvt_pk_bf16_f32 v40, v152, v153
    v_cvt_pk_bf16_f32 v41, v154, v155
    v_cvt_pk_bf16_f32 v42, v156, v157
    v_cvt_pk_bf16_f32 v43, v158, v159
    s_nop 1
    v_permlane16_swap_b32 v40, v42
    v_permlane16_swap_b32 v41, v43
    buffer_store_dwordx4 v[40:43], v1, s[20:23], s38 offen sc1
    s_add_u32 s38, s50, 230400
    s_waitcnt lgkmcnt(1)
    v_pk_fma_f32 v[56:57], v[24:25], v[8:9], v[56:57] op_sel_hi:[1,0,1]
    v_pk_fma_f32 v[58:59], v[26:27], v[8:9], v[58:59] op_sel_hi:[1,0,1]
    v_pk_fma_f32 v[60:61], v[24:25], v[12:13], v[60:61] op_sel_hi:[1,0,1]
    v_pk_fma_f32 v[62:63], v[26:27], v[12:13], v[62:63] op_sel_hi:[1,0,1]
    ds_read_b128 v[24:27], v4 offset:128
    v_pk_mul_f32 v[16:17], v[56:57], v[56:57]
    v_pk_mul_f32 v[18:19], v[58:59], v[58:59]
    v_pk_mul_f32 v[20:21], v[60:61], v[60:61]
    v_pk_mul_f32 v[22:23], v[62:63], v[62:63]
    v_pk_fma_f32 v[16:17], v[16:17], v[10:11], v[8:9] op_sel:[0,0,1] op_sel_hi:[1,0,1]
    v_pk_fma_f32 v[18:19], v[18:19], v[10:11], v[8:9] op_sel:[0,0,1] op_sel_hi:[1,0,1]
    v_pk_fma_f32 v[20:21], v[20:21], v[14:15], v[12:13] op_sel:[0,0,1] op_sel_hi:[1,0,1]
    v_pk_fma_f32 v[22:23], v[22:23], v[14:15], v[12:13] op_sel:[0,0,1] op_sel_hi:[1,0,1]
    v_pk_mul_f32 v[16:17], v[16:17], v[56:57]
    v_pk_mul_f32 v[18:19], v[18:19], v[58:59]
    v_pk_mul_f32 v[20:21], v[20:21], v[60:61]
    v_pk_mul_f32 v[22:23], v[22:23], v[62:63]
    v_exp_f32 v16, v16
    v_exp_f32 v17, v17
    v_exp_f32 v18, v18
    v_exp_f32 v19, v19
    v_exp_f32 v20, v20
    v_exp_f32 v21, v21
    v_exp_f32 v22, v22
    v_exp_f32 v23, v23
    s_waitcnt lgkmcnt(1)
    v_pk_fma_f32 v[168:169], v[28:29], v[8:9], v[168:169] op_sel_hi:[1,0,1]
    v_pk_fma_f32 v[170:171], v[30:31], v[8:9], v[170:171] op_sel_hi:[1,0,1]
    v_pk_fma_f32 v[172:173], v[28:29], v[12:13], v[172:173] op_sel_hi:[1,0,1]
    v_pk_fma_f32 v[174:175], v[30:31], v[12:13], v[174:175] op_sel_hi:[1,0,1]
    ds_read_b128 v[28:31], v4 offset:576
    v_pk_fma_f32 v[16:17], v[16:17], v[10:11], v[10:11] op_sel:[0,1,1] op_sel_hi:[1,1,1]
    v_pk_fma_f32 v[18:19], v[18:19], v[10:11], v[10:11] op_sel:[0,1,1] op_sel_hi:[1,1,1]
    v_pk_fma_f32 v[20:21], v[20:21], v[14:15], v[14:15] op_sel:[0,1,1] op_sel_hi:[1,1,1]
    v_pk_fma_f32 v[22:23], v[22:23], v[14:15], v[14:15] op_sel:[0,1,1] op_sel_hi:[1,1,1]
    v_rcp_f32 v16, v16
    v_rcp_f32 v17, v17
    v_rcp_f32 v18, v18
    v_rcp_f32 v19, v19
    v_rcp_f32 v20, v20
    v_rcp_f32 v21, v21
    v_rcp_f32 v22, v22
    v_rcp_f32 v23, v23
    v_pk_mul_f32 v[168:169], v[168:169], v[56:57]
    v_pk_mul_f32 v[170:171], v[170:171], v[58:59]
    v_pk_mul_f32 v[172:173], v[172:173], v[60:61]
    v_pk_mul_f32 v[174:175], v[174:175], v[62:63]
    v_pk_mul_f32 v[168:169], v[168:169], v[16:17]
    v_pk_mul_f32 v[170:171], v[170:171], v[18:19]
    v_pk_mul_f32 v[172:173], v[172:173], v[20:21]
    v_pk_mul_f32 v[174:175], v[174:175], v[22:23]
    v_cvt_pk_bf16_f32 v56, v168, v169
    v_cvt_pk_bf16_f32 v57, v170, v171
    v_cvt_pk_bf16_f32 v58, v172, v173
    v_cvt_pk_bf16_f32 v59, v174, v175
    s_nop 1
    v_permlane16_swap_b32 v56, v58
    v_permlane16_swap_b32 v57, v59
    buffer_store_dwordx4 v[56:59], v1, s[20:23], s38 offen sc1
    s_add_u32 s38, s50, 231424
    s_waitcnt lgkmcnt(1)
    v_pk_fma_f32 v[72:73], v[24:25], v[8:9], v[72:73] op_sel_hi:[1,0,1]
    v_pk_fma_f32 v[74:75], v[26:27], v[8:9], v[74:75] op_sel_hi:[1,0,1]
    v_pk_fma_f32 v[76:77], v[24:25], v[12:13], v[76:77] op_sel_hi:[1,0,1]
    v_pk_fma_f32 v[78:79], v[26:27], v[12:13], v[78:79] op_sel_hi:[1,0,1]
    ds_read_b128 v[24:27], v4 offset:192
    v_pk_mul_f32 v[16:17], v[72:73], v[72:73]
    v_pk_mul_f32 v[18:19], v[74:75], v[74:75]
    v_pk_mul_f32 v[20:21], v[76:77], v[76:77]
    v_pk_mul_f32 v[22:23], v[78:79], v[78:79]
    v_pk_fma_f32 v[16:17], v[16:17], v[10:11], v[8:9] op_sel:[0,0,1] op_sel_hi:[1,0,1]
    v_pk_fma_f32 v[18:19], v[18:19], v[10:11], v[8:9] op_sel:[0,0,1] op_sel_hi:[1,0,1]
    v_pk_fma_f32 v[20:21], v[20:21], v[14:15], v[12:13] op_sel:[0,0,1] op_sel_hi:[1,0,1]
    v_pk_fma_f32 v[22:23], v[22:23], v[14:15], v[12:13] op_sel:[0,0,1] op_sel_hi:[1,0,1]
    v_pk_mul_f32 v[16:17], v[16:17], v[72:73]
    v_pk_mul_f32 v[18:19], v[18:19], v[74:75]
    v_pk_mul_f32 v[20:21], v[20:21], v[76:77]
    v_pk_mul_f32 v[22:23], v[22:23], v[78:79]
    v_exp_f32 v16, v16
    v_exp_f32 v17, v17
    v_exp_f32 v18, v18
    v_exp_f32 v19, v19
    v_exp_f32 v20, v20
    v_exp_f32 v21, v21
    v_exp_f32 v22, v22
    v_exp_f32 v23, v23
    s_waitcnt lgkmcnt(1)
    v_pk_fma_f32 v[184:185], v[28:29], v[8:9], v[184:185] op_sel_hi:[1,0,1]
    v_pk_fma_f32 v[186:187], v[30:31], v[8:9], v[186:187] op_sel_hi:[1,0,1]
    v_pk_fma_f32 v[188:189], v[28:29], v[12:13], v[188:189] op_sel_hi:[1,0,1]
    v_pk_fma_f32 v[190:191], v[30:31], v[12:13], v[190:191] op_sel_hi:[1,0,1]
    ds_read_b128 v[28:31], v4 offset:640
    v_pk_fma_f32 v[16:17], v[16:17], v[10:11], v[10:11] op_sel:[0,1,1] op_sel_hi:[1,1,1]
    v_pk_fma_f32 v[18:19], v[18:19], v[10:11], v[10:11] op_sel:[0,1,1] op_sel_hi:[1,1,1]
    v_pk_fma_f32 v[20:21], v[20:21], v[14:15], v[14:15] op_sel:[0,1,1] op_sel_hi:[1,1,1]
    v_pk_fma_f32 v[22:23], v[22:23], v[14:15], v[14:15] op_sel:[0,1,1] op_sel_hi:[1,1,1]
    v_rcp_f32 v16, v16
    v_rcp_f32 v17, v17
    v_rcp_f32 v18, v18
    v_rcp_f32 v19, v19
    v_rcp_f32 v20, v20
    v_rcp_f32 v21, v21
    v_rcp_f32 v22, v22
    v_rcp_f32 v23, v23
    v_pk_mul_f32 v[184:185], v[184:185], v[72:73]
    v_pk_mul_f32 v[186:187], v[186:187], v[74:75]
    v_pk_mul_f32 v[188:189], v[188:189], v[76:77]
    v_pk_mul_f32 v[190:191], v[190:191], v[78:79]
    v_pk_mul_f32 v[184:185], v[184:185], v[16:17]
    v_pk_mul_f32 v[186:187], v[186:187], v[18:19]
    v_pk_mul_f32 v[188:189], v[188:189], v[20:21]
    v_pk_mul_f32 v[190:191], v[190:191], v[22:23]
    v_cvt_pk_bf16_f32 v72, v184, v185
    v_cvt_pk_bf16_f32 v73, v186, v187
    v_cvt_pk_bf16_f32 v74, v188, v189
    v_cvt_pk_bf16_f32 v75, v190, v191
    s_nop 1
    v_permlane16_swap_b32 v72, v74
    v_permlane16_swap_b32 v73, v75
    buffer_store_dwordx4 v[72:75], v1, s[20:23], s38 offen sc1
    s_add_u32 s38, s50, 232448
    s_waitcnt lgkmcnt(1)
    v_pk_fma_f32 v[88:89], v[24:25], v[8:9], v[88:89] op_sel_hi:[1,0,1]
    v_pk_fma_f32 v[90:91], v[26:27], v[8:9], v[90:91] op_sel_hi:[1,0,1]
    v_pk_fma_f32 v[92:93], v[24:25], v[12:13], v[92:93] op_sel_hi:[1,0,1]
    v_pk_fma_f32 v[94:95], v[26:27], v[12:13], v[94:95] op_sel_hi:[1,0,1]
    ds_read_b128 v[24:27], v4 offset:256
    v_pk_mul_f32 v[16:17], v[88:89], v[88:89]
    v_pk_mul_f32 v[18:19], v[90:91], v[90:91]
    v_pk_mul_f32 v[20:21], v[92:93], v[92:93]
    v_pk_mul_f32 v[22:23], v[94:95], v[94:95]
    v_pk_fma_f32 v[16:17], v[16:17], v[10:11], v[8:9] op_sel:[0,0,1] op_sel_hi:[1,0,1]
    v_pk_fma_f32 v[18:19], v[18:19], v[10:11], v[8:9] op_sel:[0,0,1] op_sel_hi:[1,0,1]
    v_pk_fma_f32 v[20:21], v[20:21], v[14:15], v[12:13] op_sel:[0,0,1] op_sel_hi:[1,0,1]
    v_pk_fma_f32 v[22:23], v[22:23], v[14:15], v[12:13] op_sel:[0,0,1] op_sel_hi:[1,0,1]
    v_pk_mul_f32 v[16:17], v[16:17], v[88:89]
    v_pk_mul_f32 v[18:19], v[18:19], v[90:91]
    v_pk_mul_f32 v[20:21], v[20:21], v[92:93]
    v_pk_mul_f32 v[22:23], v[22:23], v[94:95]
    v_exp_f32 v16, v16
    v_exp_f32 v17, v17
    v_exp_f32 v18, v18
    v_exp_f32 v19, v19
    v_exp_f32 v20, v20
    v_exp_f32 v21, v21
    v_exp_f32 v22, v22
    v_exp_f32 v23, v23
    s_waitcnt lgkmcnt(1)
    v_pk_fma_f32 v[200:201], v[28:29], v[8:9], v[200:201] op_sel_hi:[1,0,1]
    v_pk_fma_f32 v[202:203], v[30:31], v[8:9], v[202:203] op_sel_hi:[1,0,1]
    v_pk_fma_f32 v[204:205], v[28:29], v[12:13], v[204:205] op_sel_hi:[1,0,1]
    v_pk_fma_f32 v[206:207], v[30:31], v[12:13], v[206:207] op_sel_hi:[1,0,1]
    ds_read_b128 v[28:31], v4 offset:704
    v_pk_fma_f32 v[16:17], v[16:17], v[10:11], v[10:11] op_sel:[0,1,1] op_sel_hi:[1,1,1]
    v_pk_fma_f32 v[18:19], v[18:19], v[10:11], v[10:11] op_sel:[0,1,1] op_sel_hi:[1,1,1]
    v_pk_fma_f32 v[20:21], v[20:21], v[14:15], v[14:15] op_sel:[0,1,1] op_sel_hi:[1,1,1]
    v_pk_fma_f32 v[22:23], v[22:23], v[14:15], v[14:15] op_sel:[0,1,1] op_sel_hi:[1,1,1]
    v_rcp_f32 v16, v16
    v_rcp_f32 v17, v17
    v_rcp_f32 v18, v18
    v_rcp_f32 v19, v19
    v_rcp_f32 v20, v20
    v_rcp_f32 v21, v21
    v_rcp_f32 v22, v22
    v_rcp_f32 v23, v23
    v_pk_mul_f32 v[200:201], v[200:201], v[88:89]
    v_pk_mul_f32 v[202:203], v[202:203], v[90:91]
    v_pk_mul_f32 v[204:205], v[204:205], v[92:93]
    v_pk_mul_f32 v[206:207], v[206:207], v[94:95]
    v_pk_mul_f32 v[200:201], v[200:201], v[16:17]
    v_pk_mul_f32 v[202:203], v[202:203], v[18:19]
    v_pk_mul_f32 v[204:205], v[204:205], v[20:21]
    v_pk_mul_f32 v[206:207], v[206:207], v[22:23]
    v_cvt_pk_bf16_f32 v88, v200, v201
    v_cvt_pk_bf16_f32 v89, v202, v203
    v_cvt_pk_bf16_f32 v90, v204, v205
    v_cvt_pk_bf16_f32 v91, v206, v207
    s_nop 1
    v_permlane16_swap_b32 v88, v90
    v_permlane16_swap_b32 v89, v91
    buffer_store_dwordx4 v[88:91], v1, s[20:23], s38 offen sc1
    s_add_u32 s38, s50, 233472
    s_waitcnt lgkmcnt(1)
    v_pk_fma_f32 v[104:105], v[24:25], v[8:9], v[104:105] op_sel_hi:[1,0,1]
    v_pk_fma_f32 v[106:107], v[26:27], v[8:9], v[106:107] op_sel_hi:[1,0,1]
    v_pk_fma_f32 v[108:109], v[24:25], v[12:13], v[108:109] op_sel_hi:[1,0,1]
    v_pk_fma_f32 v[110:111], v[26:27], v[12:13], v[110:111] op_sel_hi:[1,0,1]
    ds_read_b128 v[24:27], v4 offset:320
    v_pk_mul_f32 v[16:17], v[104:105], v[104:105]
    v_pk_mul_f32 v[18:19], v[106:107], v[106:107]
    v_pk_mul_f32 v[20:21], v[108:109], v[108:109]
    v_pk_mul_f32 v[22:23], v[110:111], v[110:111]
    v_pk_fma_f32 v[16:17], v[16:17], v[10:11], v[8:9] op_sel:[0,0,1] op_sel_hi:[1,0,1]
    v_pk_fma_f32 v[18:19], v[18:19], v[10:11], v[8:9] op_sel:[0,0,1] op_sel_hi:[1,0,1]
    v_pk_fma_f32 v[20:21], v[20:21], v[14:15], v[12:13] op_sel:[0,0,1] op_sel_hi:[1,0,1]
    v_pk_fma_f32 v[22:23], v[22:23], v[14:15], v[12:13] op_sel:[0,0,1] op_sel_hi:[1,0,1]
    v_pk_mul_f32 v[16:17], v[16:17], v[104:105]
    v_pk_mul_f32 v[18:19], v[18:19], v[106:107]
    v_pk_mul_f32 v[20:21], v[20:21], v[108:109]
    v_pk_mul_f32 v[22:23], v[22:23], v[110:111]
    v_exp_f32 v16, v16
    v_exp_f32 v17, v17
    v_exp_f32 v18, v18
    v_exp_f32 v19, v19
    v_exp_f32 v20, v20
    v_exp_f32 v21, v21
    v_exp_f32 v22, v22
    v_exp_f32 v23, v23
    s_waitcnt lgkmcnt(1)
    v_pk_fma_f32 v[216:217], v[28:29], v[8:9], v[216:217] op_sel_hi:[1,0,1]
    v_pk_fma_f32 v[218:219], v[30:31], v[8:9], v[218:219] op_sel_hi:[1,0,1]
    v_pk_fma_f32 v[220:221], v[28:29], v[12:13], v[220:221] op_sel_hi:[1,0,1]
    v_pk_fma_f32 v[222:223], v[30:31], v[12:13], v[222:223] op_sel_hi:[1,0,1]
    ds_read_b128 v[28:31], v4 offset:768
    v_pk_fma_f32 v[16:17], v[16:17], v[10:11], v[10:11] op_sel:[0,1,1] op_sel_hi:[1,1,1]
    v_pk_fma_f32 v[18:19], v[18:19], v[10:11], v[10:11] op_sel:[0,1,1] op_sel_hi:[1,1,1]
    v_pk_fma_f32 v[20:21], v[20:21], v[14:15], v[14:15] op_sel:[0,1,1] op_sel_hi:[1,1,1]
    v_pk_fma_f32 v[22:23], v[22:23], v[14:15], v[14:15] op_sel:[0,1,1] op_sel_hi:[1,1,1]
    v_rcp_f32 v16, v16
    v_rcp_f32 v17, v17
    v_rcp_f32 v18, v18
    v_rcp_f32 v19, v19
    v_rcp_f32 v20, v20
    v_rcp_f32 v21, v21
    v_rcp_f32 v22, v22
    v_rcp_f32 v23, v23
    v_pk_mul_f32 v[216:217], v[216:217], v[104:105]
    v_pk_mul_f32 v[218:219], v[218:219], v[106:107]
    v_pk_mul_f32 v[220:221], v[220:221], v[108:109]
    v_pk_mul_f32 v[222:223], v[222:223], v[110:111]
    v_pk_mul_f32 v[216:217], v[216:217], v[16:17]
    v_pk_mul_f32 v[218:219], v[218:219], v[18:19]
    v_pk_mul_f32 v[220:221], v[220:221], v[20:21]
    v_pk_mul_f32 v[222:223], v[222:223], v[22:23]
    v_cvt_pk_bf16_f32 v104, v216, v217
    v_cvt_pk_bf16_f32 v105, v218, v219
    v_cvt_pk_bf16_f32 v106, v220, v221
    v_cvt_pk_bf16_f32 v107, v222, v223
    s_nop 1
    v_permlane16_swap_b32 v104, v106
    v_permlane16_swap_b32 v105, v107
    buffer_store_dwordx4 v[104:107], v1, s[20:23], s38 offen sc1
    s_add_u32 s38, s50, 234496
    s_waitcnt lgkmcnt(1)
    v_pk_fma_f32 v[120:121], v[24:25], v[8:9], v[120:121] op_sel_hi:[1,0,1]
    v_pk_fma_f32 v[122:123], v[26:27], v[8:9], v[122:123] op_sel_hi:[1,0,1]
    v_pk_fma_f32 v[124:125], v[24:25], v[12:13], v[124:125] op_sel_hi:[1,0,1]
    v_pk_fma_f32 v[126:127], v[26:27], v[12:13], v[126:127] op_sel_hi:[1,0,1]
    ds_read_b128 v[24:27], v4 offset:384
    v_pk_mul_f32 v[16:17], v[120:121], v[120:121]
    v_pk_mul_f32 v[18:19], v[122:123], v[122:123]
    v_pk_mul_f32 v[20:21], v[124:125], v[124:125]
    v_pk_mul_f32 v[22:23], v[126:127], v[126:127]
    v_pk_fma_f32 v[16:17], v[16:17], v[10:11], v[8:9] op_sel:[0,0,1] op_sel_hi:[1,0,1]
    v_pk_fma_f32 v[18:19], v[18:19], v[10:11], v[8:9] op_sel:[0,0,1] op_sel_hi:[1,0,1]
    v_pk_fma_f32 v[20:21], v[20:21], v[14:15], v[12:13] op_sel:[0,0,1] op_sel_hi:[1,0,1]
    v_pk_fma_f32 v[22:23], v[22:23], v[14:15], v[12:13] op_sel:[0,0,1] op_sel_hi:[1,0,1]
    v_pk_mul_f32 v[16:17], v[16:17], v[120:121]
    v_pk_mul_f32 v[18:19], v[18:19], v[122:123]
    v_pk_mul_f32 v[20:21], v[20:21], v[124:125]
    v_pk_mul_f32 v[22:23], v[22:23], v[126:127]
    v_exp_f32 v16, v16
    v_exp_f32 v17, v17
    v_exp_f32 v18, v18
    v_exp_f32 v19, v19
    v_exp_f32 v20, v20
    v_exp_f32 v21, v21
    v_exp_f32 v22, v22
    v_exp_f32 v23, v23
    s_waitcnt lgkmcnt(1)
    v_pk_fma_f32 v[232:233], v[28:29], v[8:9], v[232:233] op_sel_hi:[1,0,1]
    v_pk_fma_f32 v[234:235], v[30:31], v[8:9], v[234:235] op_sel_hi:[1,0,1]
    v_pk_fma_f32 v[236:237], v[28:29], v[12:13], v[236:237] op_sel_hi:[1,0,1]
    v_pk_fma_f32 v[238:239], v[30:31], v[12:13], v[238:239] op_sel_hi:[1,0,1]
    ds_read_b128 v[28:31], v4 offset:832
    v_pk_fma_f32 v[16:17], v[16:17], v[10:11], v[10:11] op_sel:[0,1,1] op_sel_hi:[1,1,1]
    v_pk_fma_f32 v[18:19], v[18:19], v[10:11], v[10:11] op_sel:[0,1,1] op_sel_hi:[1,1,1]
    v_pk_fma_f32 v[20:21], v[20:21], v[14:15], v[14:15] op_sel:[0,1,1] op_sel_hi:[1,1,1]
    v_pk_fma_f32 v[22:23], v[22:23], v[14:15], v[14:15] op_sel:[0,1,1] op_sel_hi:[1,1,1]
    v_rcp_f32 v16, v16
    v_rcp_f32 v17, v17
    v_rcp_f32 v18, v18
    v_rcp_f32 v19, v19
    v_rcp_f32 v20, v20
    v_rcp_f32 v21, v21
    v_rcp_f32 v22, v22
    v_rcp_f32 v23, v23
    v_pk_mul_f32 v[232:233], v[232:233], v[120:121]
    v_pk_mul_f32 v[234:235], v[234:235], v[122:123]
    v_pk_mul_f32 v[236:237], v[236:237], v[124:125]
    v_pk_mul_f32 v[238:239], v[238:239], v[126:127]
    v_pk_mul_f32 v[232:233], v[232:233], v[16:17]
    v_pk_mul_f32 v[234:235], v[234:235], v[18:19]
    v_pk_mul_f32 v[236:237], v[236:237], v[20:21]
    v_pk_mul_f32 v[238:239], v[238:239], v[22:23]
    v_cvt_pk_bf16_f32 v120, v232, v233
    v_cvt_pk_bf16_f32 v121, v234, v235
    v_cvt_pk_bf16_f32 v122, v236, v237
    v_cvt_pk_bf16_f32 v123, v238, v239
    s_nop 1
    v_permlane16_swap_b32 v120, v122
    v_permlane16_swap_b32 v121, v123
    buffer_store_dwordx4 v[120:123], v1, s[20:23], s38 offen sc1
    s_add_u32 s38, s50, 235520
    s_waitcnt lgkmcnt(1)
    v_pk_fma_f32 v[136:137], v[24:25], v[8:9], v[136:137] op_sel_hi:[1,0,1]
    v_pk_fma_f32 v[138:139], v[26:27], v[8:9], v[138:139] op_sel_hi:[1,0,1]
    v_pk_fma_f32 v[140:141], v[24:25], v[12:13], v[140:141] op_sel_hi:[1,0,1]
    v_pk_fma_f32 v[142:143], v[26:27], v[12:13], v[142:143] op_sel_hi:[1,0,1]
    v_pk_mul_f32 v[16:17], v[136:137], v[136:137]
    v_pk_mul_f32 v[18:19], v[138:139], v[138:139]
    v_pk_mul_f32 v[20:21], v[140:141], v[140:141]
    v_pk_mul_f32 v[22:23], v[142:143], v[142:143]
    v_pk_fma_f32 v[16:17], v[16:17], v[10:11], v[8:9] op_sel:[0,0,1] op_sel_hi:[1,0,1]
    v_pk_fma_f32 v[18:19], v[18:19], v[10:11], v[8:9] op_sel:[0,0,1] op_sel_hi:[1,0,1]
    v_pk_fma_f32 v[20:21], v[20:21], v[14:15], v[12:13] op_sel:[0,0,1] op_sel_hi:[1,0,1]
    v_pk_fma_f32 v[22:23], v[22:23], v[14:15], v[12:13] op_sel:[0,0,1] op_sel_hi:[1,0,1]
    v_pk_mul_f32 v[16:17], v[16:17], v[136:137]
    v_pk_mul_f32 v[18:19], v[18:19], v[138:139]
    v_pk_mul_f32 v[20:21], v[20:21], v[140:141]
    v_pk_mul_f32 v[22:23], v[22:23], v[142:143]
    v_exp_f32 v16, v16
    v_exp_f32 v17, v17
    v_exp_f32 v18, v18
    v_exp_f32 v19, v19
    v_exp_f32 v20, v20
    v_exp_f32 v21, v21
    v_exp_f32 v22, v22
    v_exp_f32 v23, v23
    s_waitcnt lgkmcnt(0)
    v_pk_fma_f32 v[248:249], v[28:29], v[8:9], v[248:249] op_sel_hi:[1,0,1]
    v_pk_fma_f32 v[250:251], v[30:31], v[8:9], v[250:251] op_sel_hi:[1,0,1]
    v_pk_fma_f32 v[252:253], v[28:29], v[12:13], v[252:253] op_sel_hi:[1,0,1]
    v_pk_fma_f32 v[254:255], v[30:31], v[12:13], v[254:255] op_sel_hi:[1,0,1]
    v_pk_fma_f32 v[16:17], v[16:17], v[10:11], v[10:11] op_sel:[0,1,1] op_sel_hi:[1,1,1]
    v_pk_fma_f32 v[18:19], v[18:19], v[10:11], v[10:11] op_sel:[0,1,1] op_sel_hi:[1,1,1]
    v_pk_fma_f32 v[20:21], v[20:21], v[14:15], v[14:15] op_sel:[0,1,1] op_sel_hi:[1,1,1]
    v_pk_fma_f32 v[22:23], v[22:23], v[14:15], v[14:15] op_sel:[0,1,1] op_sel_hi:[1,1,1]
    v_rcp_f32 v16, v16
    v_rcp_f32 v17, v17
    v_rcp_f32 v18, v18
    v_rcp_f32 v19, v19
    v_rcp_f32 v20, v20
    v_rcp_f32 v21, v21
    v_rcp_f32 v22, v22
    v_rcp_f32 v23, v23
    v_pk_mul_f32 v[248:249], v[248:249], v[136:137]
    v_pk_mul_f32 v[250:251], v[250:251], v[138:139]
    v_pk_mul_f32 v[252:253], v[252:253], v[140:141]
    v_pk_mul_f32 v[254:255], v[254:255], v[142:143]
    v_pk_mul_f32 v[248:249], v[248:249], v[16:17]
    v_pk_mul_f32 v[250:251], v[250:251], v[18:19]
    v_pk_mul_f32 v[252:253], v[252:253], v[20:21]
    v_pk_mul_f32 v[254:255], v[254:255], v[22:23]
    v_cvt_pk_bf16_f32 v136, v248, v249
    v_cvt_pk_bf16_f32 v137, v250, v251
    v_cvt_pk_bf16_f32 v138, v252, v253
    v_cvt_pk_bf16_f32 v139, v254, v255
    s_nop 1
    v_permlane16_swap_b32 v136, v138
    v_permlane16_swap_b32 v137, v139
    buffer_store_dwordx4 v[136:139], v1, s[20:23], s38 offen sc1
    s_waitcnt vmcnt(0)
END_k3_gateup_kernel_1:
    s_endpgm

.globl k4_down_kernel
.p2align 8
.type k4_down_kernel,@function
k4_down_kernel:
Lcode_k4_down_kernel:
    s_cmp_ge_u32 s2, 256
    s_cbranch_scc1 END_k4_down_kernel_1
    s_load_dwordx2 s[28:29], s[0:1], 88
    s_load_dwordx2 s[20:21], s[0:1], 72
    v_lshrrev_b32 v1, 6, v0
    v_and_b32 v2, 63, v0
    s_and_b32 s30, s2, 7
    s_lshr_b32 s31, s2, 3
    s_lshr_b32 s32, s30, 1
    s_lshl_b32 s32, s32, 2
    s_and_b32 s34, s31, 3
    s_add_u32 s34, s34, s32
    s_and_b32 s32, s30, 1
    s_lshl_b32 s32, s32, 3
    s_lshr_b32 s35, s31, 2
    s_add_u32 s35, s35, s32
    v_readfirstlane_b32 s58, v1
    s_lshl_b32 s37, s35, 7
    s_mul_i32 s38, s35, 458752
    s_and_b32 s33, s58, 3
    s_cmp_lt_u32 s58, 4
    s_cbranch_scc1 CONS_k4_down_kernel_2
    s_lshl_b32 s47, s33, 11
    s_add_u32 s47, s47, s38
    v_lshlrev_b32 v60, 4, v2
    v_add_u32 v8, s47, v60
    s_lshl_b32 s46, s33, 11
    s_mov_b32 s42, 0
    s_mov_b32 s41, 0
    s_waitcnt lgkmcnt(0)
    s_add_u32 s8, s28, 33554432
    s_addc_u32 s9, s29, 0
    s_mov_b32 s10, 7340032
    s_mov_b32 s11, 0x20000
    s_add_u32 m0, s42, s46
    s_nop 0
    buffer_load_dwordx4 v8, s[8:11], s41 offen offset:0 lds
    buffer_load_dwordx4 v8, s[8:11], s41 offen offset:1024 lds
    s_add_u32 s41, s41, 8192
    s_add_u32 s42, s42, 8192
    s_cmp_eq_u32 s42, 81920
    s_cselect_b32 s42, 0, s42
    s_add_u32 m0, s42, s46
    s_nop 0
    buffer_load_dwordx4 v8, s[8:11], s41 offen offset:0 lds
    buffer_load_dwordx4 v8, s[8:11], s41 offen offset:1024 lds
    s_add_u32 s41, s41, 8192
    s_add_u32 s42, s42, 8192
    s_cmp_eq_u32 s42, 81920
    s_cselect_b32 s42, 0, s42
    s_add_u32 m0, s42, s46
    s_nop 0
    buffer_load_dwordx4 v8, s[8:11], s41 offen offset:0 lds
    buffer_load_dwordx4 v8, s[8:11], s41 offen offset:1024 lds
    s_add_u32 s41, s41, 8192
    s_add_u32 s42, s42, 8192
    s_cmp_eq_u32 s42, 81920
    s_cselect_b32 s42, 0, s42
    s_add_u32 m0, s42, s46
    s_nop 0
    buffer_load_dwordx4 v8, s[8:11], s41 offen offset:0 lds
    buffer_load_dwordx4 v8, s[8:11], s41 offen offset:1024 lds
    s_add_u32 s41, s41, 8192
    s_add_u32 s42, s42, 8192
    s_cmp_eq_u32 s42, 81920
    s_cselect_b32 s42, 0, s42
    s_add_u32 m0, s42, s46
    s_nop 0
    buffer_load_dwordx4 v8, s[8:11], s41 offen offset:0 lds
    buffer_load_dwordx4 v8, s[8:11], s41 offen offset:1024 lds
    s_add_u32 s41, s41, 8192
    s_add_u32 s42, s42, 8192
    s_cmp_eq_u32 s42, 81920
    s_cselect_b32 s42, 0, s42
    s_add_u32 m0, s42, s46
    s_nop 0
    buffer_load_dwordx4 v8, s[8:11], s41 offen offset:0 lds
    buffer_load_dwordx4 v8, s[8:11], s41 offen offset:1024 lds
    s_add_u32 s41, s41, 8192
    s_add_u32 s42, s42, 8192
    s_cmp_eq_u32 s42, 81920
    s_cselect_b32 s42, 0, s42
    s_add_u32 m0, s42, s46
    s_nop 0
    buffer_load_dwordx4 v8, s[8:11], s41 offen offset:0 lds
    buffer_load_dwordx4 v8, s[8:11], s41 offen offset:1024 lds
    s_add_u32 s41, s41, 8192
    s_add_u32 s42, s42, 8192
    s_cmp_eq_u32 s42, 81920
    s_cselect_b32 s42, 0, s42
    s_add_u32 m0, s42, s46
    s_nop 0
    buffer_load_dwordx4 v8, s[8:11], s41 offen offset:0 lds
    buffer_load_dwordx4 v8, s[8:11], s41 offen offset:1024 lds
    s_add_u32 s41, s41, 8192
    s_add_u32 s42, s42, 8192
    s_cmp_eq_u32 s42, 81920
    s_cselect_b32 s42, 0, s42
    s_add_u32 m0, s42, s46
    s_nop 0
    buffer_load_dwordx4 v8, s[8:11], s41 offen offset:0 lds
    buffer_load_dwordx4 v8, s[8:11], s41 offen offset:1024 lds
    s_add_u32 s41, s41, 8192
    s_add_u32 s42, s42, 8192
    s_cmp_eq_u32 s42, 81920
    s_cselect_b32 s42, 0, s42
    s_waitcnt vmcnt(16)
    s_barrier
    s_mov_b32 s39, 47
LD_k4_down_kernel_3:
    s_waitcnt vmcnt(14)
    s_barrier
    s_add_u32 m0, s42, s46
    s_nop 0
    buffer_load_dwordx4 v8, s[8:11], s41 offen offset:0 lds
    buffer_load_dwordx4 v8, s[8:11], s41 offen offset:1024 lds
    s_add_u32 s41, s41, 8192
    s_add_u32 s42, s42, 8192
    s_cmp_eq_u32 s42, 81920
    s_cselect_b32 s42, 0, s42
    s_sub_u32 s39, s39, 1
    s_cmp_lg_u32 s39, 0
    s_cbranch_scc1 LD_k4_down_kernel_3
    s_waitcnt vmcnt(14)
    s_barrier
    s_waitcnt vmcnt(12)
    s_barrier
    s_waitcnt vmcnt(10)
    s_barrier
    s_waitcnt vmcnt(8)
    s_barrier
    s_waitcnt vmcnt(6)
    s_barrier
    s_waitcnt vmcnt(4)
    s_barrier
    s_waitcnt vmcnt(2)
    s_barrier
    s_waitcnt vmcnt(0)
    s_barrier
    s_endpgm
CONS_k4_down_kernel_2:
    s_lshr_b32 s30, s34, 1
    s_lshl_b32 s30, s30, 5
    s_lshl_b32 s31, s35, 1
    s_add_u32 s30, s30, s31
    s_lshl_b32 s30, s30, 14
    s_and_b32 s31, s34, 1
    s_lshl_b32 s31, s31, 13
    s_add_u32 s30, s30, s31
    s_lshl_b32 s31, s33, 11
    s_add_u32 s30, s30, s31
    v_bfe_u32 v60, v2, 4, 1
    v_lshlrev_b32 v60, 10, v60
    v_and_b32 v61, 15, v2
    v_lshl_add_u32 v60, v61, 4, v60
    v_lshrrev_b32 v61, 5, v2
    v_lshl_add_u32 v60, v61, 3, v60
    v_add_u32 v88, s30, v60
    v_add_u32 v89, 256, v88
    v_add_u32 v90, 512, v88
    v_add_u32 v91, 768, v88
    s_lshl_b32 s30, s34, 7
    s_lshl_b32 s31, s33, 5
    s_add_u32 s30, s30, s31
    v_and_b32 v60, 31, v2
    v_add_u32 v61, s30, v60
    v_lshlrev_b32 v60, 11, v61
    v_lshrrev_b32 v62, 5, v2
    v_lshl_add_u32 v60, v62, 5, v60
    v_add_u32 v92, s37, v60
    s_mov_b32 s48, 16384
    s_lshl_b32 s36, s34, 2
    s_add_u32 s36, s36, s33
    s_mul_i32 s36, s36, 229376
    v_lshlrev_b32 v4, 4, v2
    v_add_u32 v4, s36, v4
    v_lshrrev_b32 v60, 5, v2
    v_lshlrev_b32 v60, 3, v60
    v_bfe_u32 v61, v2, 2, 2
    v_add_u32 v60, v60, v61
    v_lshlrev_b32 v60, 7, v60
    v_and_b32 v61, 1, v2
    v_lshlrev_b32 v61, 1, v61
    v_bfe_u32 v62, v2, 4, 1
    v_add_u32 v61, v61, v62
    v_bfe_u32 v62, v2, 3, 1
    v_lshlrev_b32 v62, 2, v62
    v_xor_b32 v61, v61, v62
    v_bfe_u32 v62, v2, 1, 1
    v_lshlrev_b32 v62, 3, v62
    v_add_u32 v60, v60, v62
    v_lshl_add_u32 v14, v61, 4, v60
    v_xor_b32 v61, 4, v61
    v_lshl_add_u32 v15, v61, 4, v60
    s_mov_b32 s43, 0
    s_mov_b32 s40, 0
    v_mov_b32 v40, 0
    v_mov_b32 v41, 0
    v_mov_b32 v42, 0
    v_mov_b32 v43, 0
    v_mov_b32 v44, 0
    v_mov_b32 v45, 0
    v_mov_b32 v46, 0
    v_mov_b32 v47, 0
    v_mov_b32 v48, 0
    v_mov_b32 v49, 0
    v_mov_b32 v50, 0
    v_mov_b32 v51, 0
    v_mov_b32 v52, 0
    v_mov_b32 v53, 0
    v_mov_b32 v54, 0
    v_mov_b32 v55, 0
    v_mov_b32 v56, 0
    v_mov_b32 v57, 0
    v_mov_b32 v58, 0
    v_mov_b32 v59, 0
    v_mov_b32 v60, 0
    v_mov_b32 v61, 0
    v_mov_b32 v62, 0
    v_mov_b32 v63, 0
    v_mov_b32 v64, 0
    v_mov_b32 v65, 0
    v_mov_b32 v66, 0
    v_mov_b32 v67, 0
    v_mov_b32 v68, 0
    v_mov_b32 v69, 0
    v_mov_b32 v70, 0
    v_mov_b32 v71, 0
    s_waitcnt lgkmcnt(0)
    s_add_u32 s4, s28, 14680064
    s_addc_u32 s5, s29, 0
    s_mov_b32 s6, 14680064
    s_mov_b32 s7, 0x20000
    s_add_u32 s12, s28, 9437184
    s_addc_u32 s13, s29, 0
    s_mov_b32 s14, 4194304
    s_mov_b32 s15, 0x20000
    s_mov_b32 s22, 4194304
    s_mov_b32 s23, 0x20000
    buffer_load_dwordx4 v[128:131], v4, s[4:7], s40 offen offset:0
    buffer_load_dwordx4 v[132:135], v4, s[4:7], s40 offen offset:1024
    buffer_load_dwordx4 v[136:139], v4, s[4:7], s40 offen offset:2048
    buffer_load_dwordx4 v[140:143], v4, s[4:7], s40 offen offset:3072
    s_add_u32 s40, s40, 4096
    buffer_load_dwordx4 v[144:147], v4, s[4:7], s40 offen offset:0
    buffer_load_dwordx4 v[148:151], v4, s[4:7], s40 offen offset:1024
    buffer_load_dwordx4 v[152:155], v4, s[4:7], s40 offen offset:2048
    buffer_load_dwordx4 v[156:159], v4, s[4:7], s40 offen offset:3072
    s_add_u32 s40, s40, 4096
    buffer_load_dwordx4 v[160:163], v4, s[4:7], s40 offen offset:0
    buffer_load_dwordx4 v[164:167], v4, s[4:7], s40 offen offset:1024
    buffer_load_dwordx4 v[168:171], v4, s[4:7], s40 offen offset:2048
    buffer_load_dwordx4 v[172:175], v4, s[4:7], s40 offen offset:3072
    s_add_u32 s40, s40, 4096
    buffer_load_dwordx4 v[176:179], v4, s[4:7], s40 offen offset:0
    buffer_load_dwordx4 v[180:183], v4, s[4:7], s40 offen offset:1024
    buffer_load_dwordx4 v[184:187], v4, s[4:7], s40 offen offset:2048
    buffer_load_dwordx4 v[188:191], v4, s[4:7], s40 offen offset:3072
    s_add_u32 s40, s40, 4096
    s_setprio 1
    s_barrier
    ds_read_b64_tr_b16 v[96:97], v14 offset:0
    ds_read_b64_tr_b16 v[98:99], v14 offset:512
    ds_read_b64_tr_b16 v[100:101], v15 offset:0
    ds_read_b64_tr_b16 v[102:103], v15 offset:512
    ds_read_b64_tr_b16 v[104:105], v14 offset:2048
    ds_read_b64_tr_b16 v[106:107], v14 offset:2560
    ds_read_b64_tr_b16 v[108:109], v15 offset:2048
    ds_read_b64_tr_b16 v[110:111], v15 offset:2560
    s_mov_b32 s39, 13
CS_k4_down_kernel_4:
    s_waitcnt vmcnt(15) lgkmcnt(4)
    v_mfma_f32_32x32x16_bf16 v[40:55], v[96:99], v[128:131], v[40:55]
    ds_read_b64_tr_b16 v[112:113], v14 offset:4096
    ds_read_b64_tr_b16 v[114:115], v14 offset:4608
    v_mfma_f32_32x32x16_bf16 v[56:71], v[100:103], v[128:131], v[56:71]
    ds_read_b64_tr_b16 v[116:117], v15 offset:4096
    ds_read_b64_tr_b16 v[118:119], v15 offset:4608
    buffer_load_dwordx4 v[128:131], v4, s[4:7], s40 offen offset:0
    s_waitcnt vmcnt(15) lgkmcnt(4)
    v_mfma_f32_32x32x16_bf16 v[40:55], v[104:107], v[132:135], v[40:55]
    ds_read_b64_tr_b16 v[120:121], v14 offset:6144
    ds_read_b64_tr_b16 v[122:123], v14 offset:6656
    s_add_u32 s47, s43, 8192
    s_cmp_eq_u32 s47, 81920
    s_cselect_b32 s47, 0, s47
    s_sub_u32 s44, s47, s43
    s_mov_b32 s43, s47
    v_mfma_f32_32x32x16_bf16 v[56:71], v[108:111], v[132:135], v[56:71]
    ds_read_b64_tr_b16 v[124:125], v15 offset:6144
    ds_read_b64_tr_b16 v[126:127], v15 offset:6656
    buffer_load_dwordx4 v[132:135], v4, s[4:7], s40 offen offset:1024
    s_barrier
    v_add_u32 v14, s44, v14
    v_add_u32 v15, s44, v15
    s_waitcnt vmcnt(15) lgkmcnt(4)
    v_mfma_f32_32x32x16_bf16 v[40:55], v[112:115], v[136:139], v[40:55]
    ds_read_b64_tr_b16 v[96:97], v14 offset:0
    ds_read_b64_tr_b16 v[98:99], v14 offset:512
    v_mfma_f32_32x32x16_bf16 v[56:71], v[116:119], v[136:139], v[56:71]
    ds_read_b64_tr_b16 v[100:101], v15 offset:0
    ds_read_b64_tr_b16 v[102:103], v15 offset:512
    buffer_load_dwordx4 v[136:139], v4, s[4:7], s40 offen offset:2048
    s_waitcnt vmcnt(15) lgkmcnt(4)
    v_mfma_f32_32x32x16_bf16 v[40:55], v[120:123], v[140:143], v[40:55]
    ds_read_b64_tr_b16 v[104:105], v14 offset:2048
    ds_read_b64_tr_b16 v[106:107], v14 offset:2560
    v_mfma_f32_32x32x16_bf16 v[56:71], v[124:127], v[140:143], v[56:71]
    ds_read_b64_tr_b16 v[108:109], v15 offset:2048
    ds_read_b64_tr_b16 v[110:111], v15 offset:2560
    buffer_load_dwordx4 v[140:143], v4, s[4:7], s40 offen offset:3072
    s_add_u32 s40, s40, 4096
    s_waitcnt vmcnt(15) lgkmcnt(4)
    v_mfma_f32_32x32x16_bf16 v[40:55], v[96:99], v[144:147], v[40:55]
    ds_read_b64_tr_b16 v[112:113], v14 offset:4096
    ds_read_b64_tr_b16 v[114:115], v14 offset:4608
    v_mfma_f32_32x32x16_bf16 v[56:71], v[100:103], v[144:147], v[56:71]
    ds_read_b64_tr_b16 v[116:117], v15 offset:4096
    ds_read_b64_tr_b16 v[118:119], v15 offset:4608
    buffer_load_dwordx4 v[144:147], v4, s[4:7], s40 offen offset:0
    s_waitcnt vmcnt(15) lgkmcnt(4)
    v_mfma_f32_32x32x16_bf16 v[40:55], v[104:107], v[148:151], v[40:55]
    ds_read_b64_tr_b16 v[120:121], v14 offset:6144
    ds_read_b64_tr_b16 v[122:123], v14 offset:6656
    s_add_u32 s47, s43, 8192
    s_cmp_eq_u32 s47, 81920
    s_cselect_b32 s47, 0, s47
    s_sub_u32 s44, s47, s43
    s_mov_b32 s43, s47
    v_mfma_f32_32x32x16_bf16 v[56:71], v[108:111], v[148:151], v[56:71]
    ds_read_b64_tr_b16 v[124:125], v15 offset:6144
    ds_read_b64_tr_b16 v[126:127], v15 offset:6656
    buffer_load_dwordx4 v[148:151], v4, s[4:7], s40 offen offset:1024
    s_barrier
    v_add_u32 v14, s44, v14
    v_add_u32 v15, s44, v15
    s_waitcnt vmcnt(15) lgkmcnt(4)
    v_mfma_f32_32x32x16_bf16 v[40:55], v[112:115], v[152:155], v[40:55]
    ds_read_b64_tr_b16 v[96:97], v14 offset:0
    ds_read_b64_tr_b16 v[98:99], v14 offset:512
    v_mfma_f32_32x32x16_bf16 v[56:71], v[116:119], v[152:155], v[56:71]
    ds_read_b64_tr_b16 v[100:101], v15 offset:0
    ds_read_b64_tr_b16 v[102:103], v15 offset:512
    buffer_load_dwordx4 v[152:155], v4, s[4:7], s40 offen offset:2048
    s_waitcnt vmcnt(15) lgkmcnt(4)
    v_mfma_f32_32x32x16_bf16 v[40:55], v[120:123], v[156:159], v[40:55]
    ds_read_b64_tr_b16 v[104:105], v14 offset:2048
    ds_read_b64_tr_b16 v[106:107], v14 offset:2560
    v_mfma_f32_32x32x16_bf16 v[56:71], v[124:127], v[156:159], v[56:71]
    ds_read_b64_tr_b16 v[108:109], v15 offset:2048
    ds_read_b64_tr_b16 v[110:111], v15 offset:2560
    buffer_load_dwordx4 v[156:159], v4, s[4:7], s40 offen offset:3072
    s_add_u32 s40, s40, 4096
    s_waitcnt vmcnt(15) lgkmcnt(4)
    v_mfma_f32_32x32x16_bf16 v[40:55], v[96:99], v[160:163], v[40:55]
    ds_read_b64_tr_b16 v[112:113], v14 offset:4096
    ds_read_b64_tr_b16 v[114:115], v14 offset:4608
    v_mfma_f32_32x32x16_bf16 v[56:71], v[100:103], v[160:163], v[56:71]
    ds_read_b64_tr_b16 v[116:117], v15 offset:4096
    ds_read_b64_tr_b16 v[118:119], v15 offset:4608
    buffer_load_dwordx4 v[160:163], v4, s[4:7], s40 offen offset:0
    s_waitcnt vmcnt(15) lgkmcnt(4)
    v_mfma_f32_32x32x16_bf16 v[40:55], v[104:107], v[164:167], v[40:55]
    ds_read_b64_tr_b16 v[120:121], v14 offset:6144
    ds_read_b64_tr_b16 v[122:123], v14 offset:6656
    s_add_u32 s47, s43, 8192
    s_cmp_eq_u32 s47, 81920
    s_cselect_b32 s47, 0, s47
    s_sub_u32 s44, s47, s43
    s_mov_b32 s43, s47
    v_mfma_f32_32x32x16_bf16 v[56:71], v[108:111], v[164:167], v[56:71]
    ds_read_b64_tr_b16 v[124:125], v15 offset:6144
    ds_read_b64_tr_b16 v[126:127], v15 offset:6656
    buffer_load_dwordx4 v[164:167], v4, s[4:7], s40 offen offset:1024
    s_barrier
    v_add_u32 v14, s44, v14
    v_add_u32 v15, s44, v15
    s_waitcnt vmcnt(15) lgkmcnt(4)
    v_mfma_f32_32x32x16_bf16 v[40:55], v[112:115], v[168:171], v[40:55]
    ds_read_b64_tr_b16 v[96:97], v14 offset:0
    ds_read_b64_tr_b16 v[98:99], v14 offset:512
    v_mfma_f32_32x32x16_bf16 v[56:71], v[116:119], v[168:171], v[56:71]
    ds_read_b64_tr_b16 v[100:101], v15 offset:0
    ds_read_b64_tr_b16 v[102:103], v15 offset:512
    buffer_load_dwordx4 v[168:171], v4, s[4:7], s40 offen offset:2048
    s_waitcnt vmcnt(15) lgkmcnt(4)
    v_mfma_f32_32x32x16_bf16 v[40:55], v[120:123], v[172:175], v[40:55]
    ds_read_b64_tr_b16 v[104:105], v14 offset:2048
    ds_read_b64_tr_b16 v[106:107], v14 offset:2560
    v_mfma_f32_32x32x16_bf16 v[56:71], v[124:127], v[172:175], v[56:71]
    ds_read_b64_tr_b16 v[108:109], v15 offset:2048
    ds_read_b64_tr_b16 v[110:111], v15 offset:2560
    buffer_load_dwordx4 v[172:175], v4, s[4:7], s40 offen offset:3072
    s_add_u32 s40, s40, 4096
    s_waitcnt vmcnt(15) lgkmcnt(4)
    v_mfma_f32_32x32x16_bf16 v[40:55], v[96:99], v[176:179], v[40:55]
    ds_read_b64_tr_b16 v[112:113], v14 offset:4096
    ds_read_b64_tr_b16 v[114:115], v14 offset:4608
    v_mfma_f32_32x32x16_bf16 v[56:71], v[100:103], v[176:179], v[56:71]
    ds_read_b64_tr_b16 v[116:117], v15 offset:4096
    ds_read_b64_tr_b16 v[118:119], v15 offset:4608
    buffer_load_dwordx4 v[176:179], v4, s[4:7], s40 offen offset:0
    s_waitcnt vmcnt(15) lgkmcnt(4)
    v_mfma_f32_32x32x16_bf16 v[40:55], v[104:107], v[180:183], v[40:55]
    ds_read_b64_tr_b16 v[120:121], v14 offset:6144
    ds_read_b64_tr_b16 v[122:123], v14 offset:6656
    s_add_u32 s47, s43, 8192
    s_cmp_eq_u32 s47, 81920
    s_cselect_b32 s47, 0, s47
    s_sub_u32 s44, s47, s43
    s_mov_b32 s43, s47
    v_mfma_f32_32x32x16_bf16 v[56:71], v[108:111], v[180:183], v[56:71]
    ds_read_b64_tr_b16 v[124:125], v15 offset:6144
    ds_read_b64_tr_b16 v[126:127], v15 offset:6656
    buffer_load_dwordx4 v[180:183], v4, s[4:7], s40 offen offset:1024
    s_barrier
    v_add_u32 v14, s44, v14
    v_add_u32 v15, s44, v15
    s_waitcnt vmcnt(15) lgkmcnt(4)
    v_mfma_f32_32x32x16_bf16 v[40:55], v[112:115], v[184:187], v[40:55]
    ds_read_b64_tr_b16 v[96:97], v14 offset:0
    ds_read_b64_tr_b16 v[98:99], v14 offset:512
    v_mfma_f32_32x32x16_bf16 v[56:71], v[116:119], v[184:187], v[56:71]
    ds_read_b64_tr_b16 v[100:101], v15 offset:0
    ds_read_b64_tr_b16 v[102:103], v15 offset:512
    buffer_load_dwordx4 v[184:187], v4, s[4:7], s40 offen offset:2048
    s_waitcnt vmcnt(15) lgkmcnt(4)
    v_mfma_f32_32x32x16_bf16 v[40:55], v[120:123], v[188:191], v[40:55]
    ds_read_b64_tr_b16 v[104:105], v14 offset:2048
    ds_read_b64_tr_b16 v[106:107], v14 offset:2560
    v_mfma_f32_32x32x16_bf16 v[56:71], v[124:127], v[188:191], v[56:71]
    ds_read_b64_tr_b16 v[108:109], v15 offset:2048
    ds_read_b64_tr_b16 v[110:111], v15 offset:2560
    buffer_load_dwordx4 v[188:191], v4, s[4:7], s40 offen offset:3072
    s_add_u32 s40, s40, 4096
    s_sub_u32 s39, s39, 1
    s_cmp_lg_u32 s39, 0
    s_cbranch_scc1 CS_k4_down_kernel_4
    buffer_load_dwordx2 v[72:73], v88, s[12:15], 0 offen
    buffer_load_dwordx2 v[74:75], v89, s[12:15], 0 offen
    buffer_load_dwordx2 v[76:77], v90, s[12:15], 0 offen
    buffer_load_dwordx2 v[78:79], v91, s[12:15], 0 offen
    buffer_load_dwordx2 v[80:81], v88, s[12:15], s48 offen
    buffer_load_dwordx2 v[82:83], v89, s[12:15], s48 offen
    buffer_load_dwordx2 v[84:85], v90, s[12:15], s48 offen
    buffer_load_dwordx2 v[86:87], v91, s[12:15], s48 offen
    s_waitcnt vmcnt(23) lgkmcnt(4)
    v_mfma_f32_32x32x16_bf16 v[40:55], v[96:99], v[128:131], v[40:55]
    ds_read_b64_tr_b16 v[112:113], v14 offset:4096
    ds_read_b64_tr_b16 v[114:115], v14 offset:4608
    v_mfma_f32_32x32x16_bf16 v[56:71], v[100:103], v[128:131], v[56:71]
    ds_read_b64_tr_b16 v[116:117], v15 offset:4096
    ds_read_b64_tr_b16 v[118:119], v15 offset:4608
    s_waitcnt vmcnt(22) lgkmcnt(4)
    v_mfma_f32_32x32x16_bf16 v[40:55], v[104:107], v[132:135], v[40:55]
    ds_read_b64_tr_b16 v[120:121], v14 offset:6144
    ds_read_b64_tr_b16 v[122:123], v14 offset:6656
    s_add_u32 s47, s43, 8192
    s_cmp_eq_u32 s47, 81920
    s_cselect_b32 s47, 0, s47
    s_sub_u32 s44, s47, s43
    s_mov_b32 s43, s47
    v_mfma_f32_32x32x16_bf16 v[56:71], v[108:111], v[132:135], v[56:71]
    ds_read_b64_tr_b16 v[124:125], v15 offset:6144
    ds_read_b64_tr_b16 v[126:127], v15 offset:6656
    s_barrier
    v_add_u32 v14, s44, v14
    v_add_u32 v15, s44, v15
    s_waitcnt vmcnt(21) lgkmcnt(4)
    v_mfma_f32_32x32x16_bf16 v[40:55], v[112:115], v[136:139], v[40:55]
    ds_read_b64_tr_b16 v[96:97], v14 offset:0
    ds_read_b64_tr_b16 v[98:99], v14 offset:512
    v_mfma_f32_32x32x16_bf16 v[56:71], v[116:119], v[136:139], v[56:71]
    ds_read_b64_tr_b16 v[100:101], v15 offset:0
    ds_read_b64_tr_b16 v[102:103], v15 offset:512
    s_waitcnt vmcnt(20) lgkmcnt(4)
    v_mfma_f32_32x32x16_bf16 v[40:55], v[120:123], v[140:143], v[40:55]
    ds_read_b64_tr_b16 v[104:105], v14 offset:2048
    ds_read_b64_tr_b16 v[106:107], v14 offset:2560
    v_mfma_f32_32x32x16_bf16 v[56:71], v[124:127], v[140:143], v[56:71]
    ds_read_b64_tr_b16 v[108:109], v15 offset:2048
    ds_read_b64_tr_b16 v[110:111], v15 offset:2560
    s_waitcnt vmcnt(19) lgkmcnt(4)
    v_mfma_f32_32x32x16_bf16 v[40:55], v[96:99], v[144:147], v[40:55]
    ds_read_b64_tr_b16 v[112:113], v14 offset:4096
    ds_read_b64_tr_b16 v[114:115], v14 offset:4608
    v_mfma_f32_32x32x16_bf16 v[56:71], v[100:103], v[144:147], v[56:71]
    ds_read_b64_tr_b16 v[116:117], v15 offset:4096
    ds_read_b64_tr_b16 v[118:119], v15 offset:4608
    s_waitcnt vmcnt(18) lgkmcnt(4)
    v_mfma_f32_32x32x16_bf16 v[40:55], v[104:107], v[148:151], v[40:55]
    ds_read_b64_tr_b16 v[120:121], v14 offset:6144
    ds_read_b64_tr_b16 v[122:123], v14 offset:6656
    s_add_u32 s47, s43, 8192
    s_cmp_eq_u32 s47, 81920
    s_cselect_b32 s47, 0, s47
    s_sub_u32 s44, s47, s43
    s_mov_b32 s43, s47
    v_mfma_f32_32x32x16_bf16 v[56:71], v[108:111], v[148:151], v[56:71]
    ds_read_b64_tr_b16 v[124:125], v15 offset:6144
    ds_read_b64_tr_b16 v[126:127], v15 offset:6656
    s_barrier
    v_add_u32 v14, s44, v14
    v_add_u32 v15, s44, v15
    s_waitcnt vmcnt(17) lgkmcnt(4)
    v_mfma_f32_32x32x16_bf16 v[40:55], v[112:115], v[152:155], v[40:55]
    ds_read_b64_tr_b16 v[96:97], v14 offset:0
    ds_read_b64_tr_b16 v[98:99], v14 offset:512
    v_mfma_f32_32x32x16_bf16 v[56:71], v[116:119], v[152:155], v[56:71]
    ds_read_b64_tr_b16 v[100:101], v15 offset:0
    ds_read_b64_tr_b16 v[102:103], v15 offset:512
    s_waitcnt vmcnt(16) lgkmcnt(4)
    v_mfma_f32_32x32x16_bf16 v[40:55], v[120:123], v[156:159], v[40:55]
    ds_read_b64_tr_b16 v[104:105], v14 offset:2048
    ds_read_b64_tr_b16 v[106:107], v14 offset:2560
    v_mfma_f32_32x32x16_bf16 v[56:71], v[124:127], v[156:159], v[56:71]
    ds_read_b64_tr_b16 v[108:109], v15 offset:2048
    ds_read_b64_tr_b16 v[110:111], v15 offset:2560
    s_waitcnt vmcnt(15) lgkmcnt(4)
    v_mfma_f32_32x32x16_bf16 v[40:55], v[96:99], v[160:163], v[40:55]
    ds_read_b64_tr_b16 v[112:113], v14 offset:4096
    ds_read_b64_tr_b16 v[114:115], v14 offset:4608
    v_mfma_f32_32x32x16_bf16 v[56:71], v[100:103], v[160:163], v[56:71]
    ds_read_b64_tr_b16 v[116:117], v15 offset:4096
    ds_read_b64_tr_b16 v[118:119], v15 offset:4608
    s_waitcnt vmcnt(14) lgkmcnt(4)
    v_mfma_f32_32x32x16_bf16 v[40:55], v[104:107], v[164:167], v[40:55]
    ds_read_b64_tr_b16 v[120:121], v14 offset:6144
    ds_read_b64_tr_b16 v[122:123], v14 offset:6656
    s_add_u32 s47, s43, 8192
    s_cmp_eq_u32 s47, 81920
    s_cselect_b32 s47, 0, s47
    s_sub_u32 s44, s47, s43
    s_mov_b32 s43, s47
    v_mfma_f32_32x32x16_bf16 v[56:71], v[108:111], v[164:167], v[56:71]
    ds_read_b64_tr_b16 v[124:125], v15 offset:6144
    ds_read_b64_tr_b16 v[126:127], v15 offset:6656
    s_barrier
    v_add_u32 v14, s44, v14
    v_add_u32 v15, s44, v15
    s_waitcnt vmcnt(13) lgkmcnt(4)
    v_mfma_f32_32x32x16_bf16 v[40:55], v[112:115], v[168:171], v[40:55]
    ds_read_b64_tr_b16 v[96:97], v14 offset:0
    ds_read_b64_tr_b16 v[98:99], v14 offset:512
    v_mfma_f32_32x32x16_bf16 v[56:71], v[116:119], v[168:171], v[56:71]
    ds_read_b64_tr_b16 v[100:101], v15 offset:0
    ds_read_b64_tr_b16 v[102:103], v15 offset:512
    s_waitcnt vmcnt(12) lgkmcnt(4)
    v_mfma_f32_32x32x16_bf16 v[40:55], v[120:123], v[172:175], v[40:55]
    ds_read_b64_tr_b16 v[104:105], v14 offset:2048
    ds_read_b64_tr_b16 v[106:107], v14 offset:2560
    v_mfma_f32_32x32x16_bf16 v[56:71], v[124:127], v[172:175], v[56:71]
    ds_read_b64_tr_b16 v[108:109], v15 offset:2048
    ds_read_b64_tr_b16 v[110:111], v15 offset:2560
    s_waitcnt vmcnt(11) lgkmcnt(4)
    v_mfma_f32_32x32x16_bf16 v[40:55], v[96:99], v[176:179], v[40:55]
    ds_read_b64_tr_b16 v[112:113], v14 offset:4096
    ds_read_b64_tr_b16 v[114:115], v14 offset:4608
    v_mfma_f32_32x32x16_bf16 v[56:71], v[100:103], v[176:179], v[56:71]
    ds_read_b64_tr_b16 v[116:117], v15 offset:4096
    ds_read_b64_tr_b16 v[118:119], v15 offset:4608
    s_waitcnt vmcnt(10) lgkmcnt(4)
    v_mfma_f32_32x32x16_bf16 v[40:55], v[104:107], v[180:183], v[40:55]
    ds_read_b64_tr_b16 v[120:121], v14 offset:6144
    ds_read_b64_tr_b16 v[122:123], v14 offset:6656
    v_mfma_f32_32x32x16_bf16 v[56:71], v[108:111], v[180:183], v[56:71]
    ds_read_b64_tr_b16 v[124:125], v15 offset:6144
    ds_read_b64_tr_b16 v[126:127], v15 offset:6656
    s_waitcnt vmcnt(9) lgkmcnt(4)
    v_mfma_f32_32x32x16_bf16 v[40:55], v[112:115], v[184:187], v[40:55]
    v_mfma_f32_32x32x16_bf16 v[56:71], v[116:119], v[184:187], v[56:71]
    s_waitcnt vmcnt(8) lgkmcnt(0)
    v_mfma_f32_32x32x16_bf16 v[40:55], v[120:123], v[188:191], v[40:55]
    v_mfma_f32_32x32x16_bf16 v[56:71], v[124:127], v[188:191], v[56:71]
    s_setprio 0
    s_waitcnt vmcnt(0)
    v_lshlrev_b32 v16, 16, v72
    v_and_b32 v17, 0xffff0000, v72
    v_lshlrev_b32 v18, 16, v73
    v_and_b32 v19, 0xffff0000, v73
    v_lshlrev_b32 v20, 16, v74
    v_and_b32 v21, 0xffff0000, v74
    v_lshlrev_b32 v22, 16, v75
    v_and_b32 v23, 0xffff0000, v75
    v_lshlrev_b32 v24, 16, v76
    v_and_b32 v25, 0xffff0000, v76
    v_lshlrev_b32 v26, 16, v77
    v_and_b32 v27, 0xffff0000, v77
    v_lshlrev_b32 v28, 16, v78
    v_and_b32 v29, 0xffff0000, v78
    v_lshlrev_b32 v30, 16, v79
    v_and_b32 v31, 0xffff0000, v79
    s_nop 1
    v_pk_add_f32 v[40:41], v[40:41], v[16:17]
    v_pk_add_f32 v[42:43], v[42:43], v[18:19]
    v_pk_add_f32 v[44:45], v[44:45], v[20:21]
    v_pk_add_f32 v[46:47], v[46:47], v[22:23]
    v_pk_add_f32 v[48:49], v[48:49], v[24:25]
    v_pk_add_f32 v[50:51], v[50:51], v[26:27]
    v_pk_add_f32 v[52:53], v[52:53], v[28:29]
    v_pk_add_f32 v[54:55], v[54:55], v[30:31]
    v_lshlrev_b32 v16, 16, v80
    v_and_b32 v17, 0xffff0000, v80
    v_lshlrev_b32 v18, 16, v81
    v_and_b32 v19, 0xffff0000, v81
    v_lshlrev_b32 v20, 16, v82
    v_and_b32 v21, 0xffff0000, v82
    v_lshlrev_b32 v22, 16, v83
    v_and_b32 v23, 0xffff0000, v83
    v_lshlrev_b32 v24, 16, v84
    v_and_b32 v25, 0xffff0000, v84
    v_lshlrev_b32 v26, 16, v85
    v_and_b32 v27, 0xffff0000, v85
    v_lshlrev_b32 v28, 16, v86
    v_and_b32 v29, 0xffff0000, v86
    v_lshlrev_b32 v30, 16, v87
    v_and_b32 v31, 0xffff0000, v87
    v_pk_add_f32 v[56:57], v[56:57], v[16:17]
    v_pk_add_f32 v[58:59], v[58:59], v[18:19]
    v_pk_add_f32 v[60:61], v[60:61], v[20:21]
    v_pk_add_f32 v[62:63], v[62:63], v[22:23]
    v_pk_add_f32 v[64:65], v[64:65], v[24:25]
    v_pk_add_f32 v[66:67], v[66:67], v[26:27]
    v_pk_add_f32 v[68:69], v[68:69], v[28:29]
    v_pk_add_f32 v[70:71], v[70:71], v[30:31]
    v_cvt_pk_bf16_f32 v72, v40, v41
    v_cvt_pk_bf16_f32 v73, v42, v43
    v_cvt_pk_bf16_f32 v74, v44, v45
    v_cvt_pk_bf16_f32 v75, v46, v47
    v_cvt_pk_bf16_f32 v76, v48, v49
    v_cvt_pk_bf16_f32 v77, v50, v51
    v_cvt_pk_bf16_f32 v78, v52, v53
    v_cvt_pk_bf16_f32 v79, v54, v55
    v_cvt_pk_bf16_f32 v80, v56, v57
    v_cvt_pk_bf16_f32 v81, v58, v59
    v_cvt_pk_bf16_f32 v82, v60, v61
    v_cvt_pk_bf16_f32 v83, v62, v63
    v_cvt_pk_bf16_f32 v84, v64, v65
    v_cvt_pk_bf16_f32 v85, v66, v67
    v_cvt_pk_bf16_f32 v86, v68, v69
    v_cvt_pk_bf16_f32 v87, v70, v71
    s_lshl_b32 s30, s33, 12
    s_add_u32 s30, s30, 81920
    v_and_b32 v16, 31, v2
    v_lshlrev_b32 v17, 7, v16
    v_add_u32 v17, s30, v17
    v_lshrrev_b32 v18, 5, v2
    v_lshlrev_b32 v18, 1, v18
    v_and_b32 v19, 7, v2
    v_or_b32 v20, 0, v18
    v_xor_b32 v20, v20, v19
    v_lshl_add_u32 v20, v20, 4, v17
    ds_write_b128 v20, v[72:75]
    v_or_b32 v20, 1, v18
    v_xor_b32 v20, v20, v19
    v_lshl_add_u32 v20, v20, 4, v17
    ds_write_b128 v20, v[76:79]
    v_or_b32 v20, 4, v18
    v_xor_b32 v20, v20, v19
    v_lshl_add_u32 v20, v20, 4, v17
    ds_write_b128 v20, v[80:83]
    v_or_b32 v20, 5, v18
    v_xor_b32 v20, v20, v19
    v_lshl_add_u32 v20, v20, 4, v17
    ds_write_b128 v20, v[84:87]
    v_lshrrev_b32 v16, 3, v2
    v_and_b32 v18, 7, v2
    v_xor_b32 v19, v18, v16
    v_lshlrev_b32 v17, 7, v16
    v_lshl_add_u32 v17, v19, 4, v17
    v_add_u32 v17, s30, v17
    s_lshl_b32 s30, s34, 7
    s_lshl_b32 s31, s33, 5
    s_add_u32 s30, s30, s31
    v_add_u32 v16, s30, v16
    v_lshlrev_b32 v16, 11, v16
    v_lshl_add_u32 v16, v18, 4, v16
    v_add_u32 v16, s37, v16
    s_waitcnt lgkmcnt(0)
    ds_read_b128 v[24:27], v17 offset:0
    ds_read_b128 v[28:31], v17 offset:1024
    ds_read_b128 v[32:35], v17 offset:2048
    ds_read_b128 v[36:39], v17 offset:3072
    s_waitcnt lgkmcnt(3)
    s_mov_b32 s31, 0
    buffer_store_dwordx4 v[24:27], v16, s[20:23], s31 offen sc1
    s_waitcnt lgkmcnt(2)
    s_mov_b32 s31, 16384
    buffer_store_dwordx4 v[28:31], v16, s[20:23], s31 offen sc1
    s_waitcnt lgkmcnt(1)
    s_mov_b32 s31, 32768
    buffer_store_dwordx4 v[32:35], v16, s[20:23], s31 offen sc1
    s_waitcnt lgkmcnt(0)
    s_mov_b32 s31, 49152
    buffer_store_dwordx4 v[36:39], v16, s[20:23], s31 offen sc1
    s_waitcnt vmcnt(0)
END_k4_down_kernel_1:
    s_endpgm

Lcode_end:
.section .rodata,"a"
.p2align 6
Lkd_first:
.p2align 6
.amdhsa_kernel k0_ln_kv_kernel
  .amdhsa_next_free_vgpr 140
  .amdhsa_next_free_sgpr 64
  .amdhsa_accum_offset 140
  .amdhsa_group_segment_fixed_size 0
  .amdhsa_kernarg_size 96
  .amdhsa_user_sgpr_count 2
  .amdhsa_user_sgpr_kernarg_segment_ptr 1
  .amdhsa_system_sgpr_workgroup_id_x 1
  .amdhsa_float_denorm_mode_32 3
.end_amdhsa_kernel

.p2align 6
.amdhsa_kernel k1_q_attn_kernel
  .amdhsa_next_free_vgpr 224
  .amdhsa_next_free_sgpr 96
  .amdhsa_accum_offset 224
  .amdhsa_group_segment_fixed_size 0
  .amdhsa_kernarg_size 96
  .amdhsa_user_sgpr_count 2
  .amdhsa_user_sgpr_kernarg_segment_ptr 1
  .amdhsa_system_sgpr_workgroup_id_x 1
  .amdhsa_float_denorm_mode_32 3
.end_amdhsa_kernel

.p2align 6
.amdhsa_kernel k2_wo_kernel
  .amdhsa_next_free_vgpr 208
  .amdhsa_next_free_sgpr 80
  .amdhsa_accum_offset 208
  .amdhsa_group_segment_fixed_size 0
  .amdhsa_kernarg_size 96
  .amdhsa_user_sgpr_count 2
  .amdhsa_user_sgpr_kernarg_segment_ptr 1
  .amdhsa_system_sgpr_workgroup_id_x 1
  .amdhsa_float_denorm_mode_32 3
.end_amdhsa_kernel

.p2align 6
.amdhsa_kernel k3_gateup_kernel
  .amdhsa_next_free_vgpr 376
  .amdhsa_next_free_sgpr 96
  .amdhsa_accum_offset 256
  .amdhsa_group_segment_fixed_size 0
  .amdhsa_kernarg_size 96
  .amdhsa_user_sgpr_count 2
  .amdhsa_user_sgpr_kernarg_segment_ptr 1
  .amdhsa_system_sgpr_workgroup_id_x 1
  .amdhsa_float_denorm_mode_32 3
.end_amdhsa_kernel

.p2align 6
.amdhsa_kernel k4_down_kernel
  .amdhsa_next_free_vgpr 208
  .amdhsa_next_free_sgpr 80
  .amdhsa_accum_offset 208
  .amdhsa_group_segment_fixed_size 0
  .amdhsa_kernarg_size 96
  .amdhsa_user_sgpr_count 2
  .amdhsa_user_sgpr_kernarg_segment_ptr 1
  .amdhsa_system_sgpr_workgroup_id_x 1
  .amdhsa_float_denorm_mode_32 3
.end_amdhsa_kernel
```
